```python
import torch

def _softmax(x, axis=-1):
    return torch.softmax(x, dim=axis)
def _gelu(x):
    return torch.nn.functional.gelu(x, approximate="tanh")
def _silu(x):
    return torch.nn.functional.silu(x)
def _sigmoid(x):
    return torch.sigmoid(x)
def _layernorm(x, axis=-1, eps=1e-5):
    m = x.mean(dim=axis, keepdim=True)
    v = x.var(dim=axis, keepdim=True, unbiased=False)
    return (x - m) / torch.sqrt(v + eps)
def _scatter_add(tgt, idx, src, axis=0):
    return tgt.clone().index_add_(axis, idx, src)
def _segment_sum(src, seg, n):
    out = torch.zeros((n,) + src.shape[1:], dtype=src.dtype)
    return out.index_add_(0, seg, src)
def _pad(x, pw):
    flat = tuple(v for pair in reversed(pw) for v in pair)
    return torch.nn.functional.pad(x, flat)

kernel_name = 'parallel_sum__linear_attn_block__dense_activation_relu__prompt'

def setup_inputs():

    _w = (lambda a: (lambda t: t.to(torch.bfloat16) if t.is_floating_point() else t)(torch.as_tensor(a)))
    def _A_setup():
        B, S, D = 1, 2048, 512
        return {
            "x": _w((lambda *s: torch.randn(*s, dtype=torch.bfloat16) * 0.05)(B, S, D)),
            "wqkv": _w((lambda *s: torch.randn(*s, dtype=torch.bfloat16) * 0.2)(D, 3 * D)),
            "wo": _w((lambda *s: torch.randn(*s, dtype=torch.bfloat16) * 0.2)(D, D)),
        }
    _A_in = _A_setup()

    def _B_setup():
        B, S, D, Dff = 1, 2048, 512, 1376
        return {
            "x": _w((lambda *s: torch.randn(*s, dtype=torch.bfloat16) * 0.05)(B, S, D)),
            "w1": _w((lambda *s: torch.randn(*s, dtype=torch.bfloat16) * 0.05)(D, Dff)),
            "w2": _w((lambda *s: torch.randn(*s, dtype=torch.bfloat16) * 0.05)(Dff, D)),
        }
    _B_in = _B_setup()

    return {
        "A_x": _A_in["x"],
        "A_wqkv": _A_in["wqkv"],
        "A_wo": _A_in["wo"],
        "B_x": _B_in["x"],
        "B_w1": _B_in["w1"],
        "B_w2": _B_in["w2"],
    }

def reference(A_x, A_wqkv, A_wo, B_x, B_w1, B_w2):
    def _A_ref(x, wqkv, wo):
        B, S, D = x.shape
        H = 32; Dh = D // H
        qkv = (lambda x, *d: x.permute(*d))((x @ wqkv).reshape(B, S, 3, H, Dh), 2, 0, 3, 1, 4)
        q, k, v = qkv[0], qkv[1], qkv[2]
        phi = lambda t: torch.where(t > 0, t + 1, torch.exp(t)) + 1e-6
        pq, pk = phi(q), phi(k)
        kv = torch.einsum("bhsd,bhse->bhde", pk, v)
        z = torch.einsum("bhsd->bhd", pk)
        num = torch.einsum("bhqd,bhde->bhqe", pq, kv)
        den = torch.einsum("bhqd,bhd->bhq", pq, z)[..., None] + 1e-6
        o = num / den
        return (lambda x, *d: x.permute(*d))(o, 0, 2, 1, 3).reshape(B, S, D) @ wo

    def _B_ref(x, w1, w2):
        h = torch.einsum("bsd,df->bsf", x, w1)
        zero = torch.zeros_like(h)
        h = torch.maximum(h, zero)
        return torch.einsum("bsf,fd->bsd", h, w2)

    x = A_x
    xn = _layernorm(x, axis=-1)
    return x + _A_ref(xn, A_wqkv, A_wo) + _B_ref(xn, B_w1, B_w2)
```

```asm
; @launch grid=(256,1,1) block=(256,1,1) lds=163840
.amdgcn_target "amdgcn-amd-amdhsa--gfx950"
.text
.globl parallel_sum__linear_attn_block__dense_activation_relu__prompt_kernel
.p2align 8
.type parallel_sum__linear_attn_block__dense_activation_relu__prompt_kernel,@function
parallel_sum__linear_attn_block__dense_activation_relu__prompt_kernel:
    s_cmp_ge_u32 s2, 256
    s_cbranch_scc1 L_END
    s_load_dwordx16 s[4:19], s[0:1], 0
    s_load_dwordx2 s[20:21], s[0:1], 64
    s_getpc_b64 s[22:23]
    s_bfe_u32 s24, s2, 0x30003
    s_mulk_i32 s24, 5120
    v_mul_u32_u24 v252, 20, v0
    v_add_u32 v252, s24, v252
    v_min_u32 v252, L_END-parallel_sum__linear_attn_block__dense_activation_relu__prompt_kernel-256, v252
    global_load_dword v253, v252, s[22:23]
    v_and_b32 v1, 63, v0
    v_lshrrev_b32 v2, 6, v0
    s_and_b32 s88, s2, 7
    v_readfirstlane_b32 s59, v2
    s_lshr_b32 s89, s2, 3
    s_and_b32 s56, s88, 3
    s_lshl_b32 s56, s56, 2
    s_lshr_b32 s90, s89, 3
    s_add_u32 s56, s56, s90
    s_lshl_b32 s62, s88, 2
    s_add_u32 s62, s62, s90
    s_and_b32 s63, s89, 7
    s_and_b32 s57, s63, 1
    s_lshr_b32 s58, s88, 2
    s_lshl_b32 s58, s58, 2
    s_lshr_b32 s88, s63, 1
    s_add_u32 s58, s58, s88
    s_lshl_b32 s91, s90, 1
    s_add_u32 s91, s91, s63
    v_lshrrev_b32 v12, 3, v1
    v_and_b32 v13, 7, v1
    v_lshrrev_b32 v14, 1, v12
    v_xor_b32 v15, v13, v14
    v_lshlrev_b32 v15, 4, v15
    v_lshl_add_u32 v2, v12, 10, v15
    v_xor_b32 v3, 64, v2
    v_add_u32 v4, 14336, v2
    v_add_u32 v5, 21504, v3
    v_add_u32 v3, 7168, v3
    v_and_b32 v14, 1, v14
    v_lshlrev_b32 v14, 2, v14
    v_xor_b32 v15, v13, v14
    v_lshlrev_b32 v15, 4, v15
    s_movk_i32 s97, 2752
    s_movk_i32 s96, 3072
    s_cmp_eq_u32 s57, 0
    s_cselect_b32 s98, s96, s97
    s_cselect_b32 s99, s97, s96
    v_mad_u32_u24 v6, s98, v12, v15
    s_lshl_b32 s100, s98, 3
    s_sub_u32 s100, s100, 1024
    v_add_u32 v7, s100, v6
    s_lshl_b32 s92, s56, 7
    s_lshl_b32 s88, s59, 5
    s_add_u32 s92, s92, s88
    s_lshl_b32 s92, s92, 10
    s_lshl_b32 s93, s59, 4
    s_add_u32 s88, s91, 0
    s_and_b32 s88, s88, 7
    s_lshl_b32 s64, s88, 7
    s_add_u32 s64, s64, s92
    s_lshl_b32 s88, s88, 6
    s_add_u32 s88, s88, s93
    s_mul_i32 s72, s88, s98
    s_mul_i32 s80, s88, s99
    s_add_u32 s88, s91, 1
    s_and_b32 s88, s88, 7
    s_lshl_b32 s65, s88, 7
    s_add_u32 s65, s65, s92
    s_lshl_b32 s88, s88, 6
    s_add_u32 s88, s88, s93
    s_mul_i32 s73, s88, s98
    s_mul_i32 s81, s88, s99
    s_add_u32 s88, s91, 2
    s_and_b32 s88, s88, 7
    s_lshl_b32 s66, s88, 7
    s_add_u32 s66, s66, s92
    s_lshl_b32 s88, s88, 6
    s_add_u32 s88, s88, s93
    s_mul_i32 s74, s88, s98
    s_mul_i32 s82, s88, s99
    s_lshl_b32 s95, s58, 7
    s_add_u32 s95, s95, 1024
    s_lshr_b32 s88, s58, 1
    s_mul_i32 s88, s88, 704
    s_and_b32 s89, s58, 1
    s_lshl_b32 s89, s89, 7
    s_add_u32 s88, s88, s89
    s_lshl_b32 s30, s98, 9
    s_lshl_b32 s34, s99, 9
    s_mov_b32 s31, 0x00020000
    s_mov_b32 s35, 0x00020000
    s_mov_b32 s26, 2097152
    s_mov_b32 s27, 0x00020000
    s_cmp_eq_u32 s57, 0
    s_cselect_b32 s95, s95, s88
    s_waitcnt lgkmcnt(0)
    s_cselect_b32 s28, s6, s12
    s_cselect_b32 s29, s7, s13
    s_cselect_b32 s32, s12, s6
    s_cselect_b32 s33, s13, s7
    s_mov_b32 s24, s4
    s_and_b32 s25, s5, 0xffff
    s_and_b32 s29, s29, 0xffff
    s_mov_b32 s48, s8
    s_and_b32 s49, s9, 0xffff
    s_mov_b32 s4, s95
    s_lshl_b32 s7, s59, 12
    s_lshl_b32 s8, s59, 11
    s_and_b32 s33, s33, 0xffff
    s_and_b32 s89, s62, 3
    s_lshl_b32 s89, s89, 3
    s_add_u32 s89, s89, s63
    s_mul_i32 s89, s89, 49152
    s_lshr_b32 s90, s58, 2
    s_lshl_b32 s90, s90, 2
    s_or_b32 s90, s90, s59
    s_lshl_b32 s90, s90, 1
    s_or_b32 s90, s90, s57
    v_lshlrev_b32 v252, 10, v1
    s_mov_b32 exec_hi, 0xffff
    s_cmp_eq_u32 s90, 4
    s_cselect_b32 s88, s89, 1073741824
    buffer_load_dword v253, v252, s[28:31], s88 offen offset:384
    s_cmp_eq_u32 s90, 5
    s_cselect_b32 s88, s89, 1073741824
    buffer_load_dword v253, v252, s[32:35], s88 offen offset:384
    s_mov_b64 exec, -1
    s_add_u32 m0, s7, 0
    s_nop 0
    buffer_load_dwordx4 v2, s[24:27], s64 offen offset:0 lds
    buffer_load_dwordx4 v3, s[24:27], s64 offen offset:1024 lds
    buffer_load_dwordx4 v4, s[24:27], s64 offen offset:2048 lds
    buffer_load_dwordx4 v5, s[24:27], s64 offen offset:3072 lds
    s_add_u32 m0, s8, 65536
    s_add_u32 s88, s72, s4
    buffer_load_dwordx4 v6, s[28:31], s88 offen lds
    buffer_load_dwordx4 v7, s[28:31], s88 offen offset:1024 lds
    s_add_u32 m0, s7, 16384
    s_nop 0
    buffer_load_dwordx4 v2, s[24:27], s65 offen offset:0 lds
    buffer_load_dwordx4 v3, s[24:27], s65 offen offset:1024 lds
    buffer_load_dwordx4 v4, s[24:27], s65 offen offset:2048 lds
    buffer_load_dwordx4 v5, s[24:27], s65 offen offset:3072 lds
    s_add_u32 m0, s8, 73728
    s_add_u32 s88, s73, s4
    buffer_load_dwordx4 v6, s[28:31], s88 offen lds
    buffer_load_dwordx4 v7, s[28:31], s88 offen offset:1024 lds
    s_and_b32 s33, s33, 0xffff
    s_mov_b32 s50, 524288
    s_mov_b32 s51, 0x00020000
    s_mov_b32 s36, s20
    s_and_b32 s37, s21, 0xffff
    s_mov_b32 s38, 268435456
    s_mov_b32 s39, 0x00020000
    s_mov_b32 s40, s18
    s_and_b32 s41, s19, 0xffff
    s_mov_b32 s42, 256
    s_mov_b32 s43, 0x00020000
    s_mov_b32 s44, s14
    s_and_b32 s45, s15, 0xffff
    s_mov_b32 s46, 1409024
    s_mov_b32 s47, 0x00020000
    s_mov_b32 s52, s16
    s_and_b32 s53, s17, 0xffff
    s_mov_b32 s54, 2097152
    s_mov_b32 s55, 0x00020000
    s_lshr_b32 s60, s59, 1
    s_and_b32 s61, s59, 1
    s_add_u32 s88, s91, 3
    s_and_b32 s88, s88, 7
    s_lshl_b32 s67, s88, 7
    s_add_u32 s67, s67, s92
    s_lshl_b32 s88, s88, 6
    s_add_u32 s88, s88, s93
    s_mul_i32 s75, s88, s98
    s_mul_i32 s83, s88, s99
    s_add_u32 s88, s91, 4
    s_and_b32 s88, s88, 7
    s_lshl_b32 s68, s88, 7
    s_add_u32 s68, s68, s92
    s_lshl_b32 s88, s88, 6
    s_add_u32 s88, s88, s93
    s_mul_i32 s76, s88, s98
    s_mul_i32 s84, s88, s99
    s_add_u32 s88, s91, 5
    s_and_b32 s88, s88, 7
    s_lshl_b32 s69, s88, 7
    s_add_u32 s69, s69, s92
    s_lshl_b32 s88, s88, 6
    s_add_u32 s88, s88, s93
    s_mul_i32 s77, s88, s98
    s_mul_i32 s85, s88, s99
    s_add_u32 s88, s91, 6
    s_and_b32 s88, s88, 7
    s_lshl_b32 s70, s88, 7
    s_add_u32 s70, s70, s92
    s_lshl_b32 s88, s88, 6
    s_add_u32 s88, s88, s93
    s_mul_i32 s78, s88, s98
    s_mul_i32 s86, s88, s99
    s_add_u32 s88, s91, 7
    s_and_b32 s88, s88, 7
    s_lshl_b32 s71, s88, 7
    s_add_u32 s71, s71, s92
    s_lshl_b32 s88, s88, 6
    s_add_u32 s88, s88, s93
    s_mul_i32 s79, s88, s98
    s_mul_i32 s87, s88, s99
    s_xor_b32 s89, s57, 0
    s_or_b32 s89, s56, s89
    s_or_b32 s89, s89, s59
    s_cmp_eq_u32 s89, 0
    s_cselect_b32 s12, 1, 0
    s_cbranch_scc0 L_NOZ
    s_memrealtime s[92:93]
    v_lshlrev_b32 v28, 4, v1
    v_mov_b32 v212, 0
    v_mov_b32 v213, 0
    v_mov_b32 v214, 0
    v_mov_b32 v215, 0
    s_mul_i32 s89, s58, 4352
    s_add_u32 s89, s89, 10485760
    buffer_store_dwordx4 v[212:215], v28, s[36:39], s89 offen offset:0 sc1
    buffer_store_dwordx4 v[212:215], v28, s[36:39], s89 offen offset:1024 sc1
    buffer_store_dwordx4 v[212:215], v28, s[36:39], s89 offen offset:2048 sc1
    buffer_store_dwordx4 v[212:215], v28, s[36:39], s89 offen offset:3072 sc1
    s_add_u32 s89, s89, 4096
    s_mov_b64 exec, 0xffff
    buffer_store_dwordx4 v[212:215], v28, s[36:39], s89 offen sc1
    s_mov_b64 exec, 1
    s_waitcnt lgkmcnt(0)
    s_or_b32 s92, s92, 1
    v_mov_b32 v216, s92
    v_mov_b32 v217, s93
    s_cmp_eq_u32 s58, 0
    s_cselect_b32 s89, 64, 1073741824
    buffer_store_dwordx2 v[216:217], v212, s[40:43], s89 offen sc1
    s_mov_b64 exec, -1
    s_nop 1
L_NOZ:
    v_mad_u32_u24 v8, s99, v12, v15
    s_lshl_b32 s100, s99, 3
    s_sub_u32 s100, s100, 1024
    v_add_u32 v9, s100, v8
    v_lshl_add_u32 v10, v12, 10, v15
    v_add_u32 v11, 7168, v10
    s_and_b32 s88, s58, 1
    s_cmp_eq_u32 s58, 6
    s_cselect_b32 s88, 1, s88
    s_and_b32 s101, s88, s57
    v_bfe_u32 v31, v15, 6, 1
    v_and_b32 v31, s101, v31
    v_lshlrev_b32 v31, 30, v31
    v_and_b32 v212, 31, v1
    v_lshrrev_b32 v213, 5, v1
    v_bfe_u32 v214, v1, 1, 3
    s_lshl_b32 s89, s60, 6
    s_lshl_b32 s88, s61, 5
    s_add_u32 s89, s89, s88
    v_add_u32 v215, s89, v212
    v_lshlrev_b32 v216, 7, v215
    s_xor_b32 s88, s60, 0
    s_lshl_b32 s88, s88, 1
    v_add_u32 v217, s88, v213
    v_xor_b32 v217, v217, v214
    v_lshl_add_u32 v12, v217, 4, v216
    v_xor_b32 v16, 0x1000, v12
    s_xor_b32 s88, s60, 1
    s_lshl_b32 s88, s88, 1
    v_add_u32 v217, s88, v213
    v_xor_b32 v217, v217, v214
    v_lshl_add_u32 v13, v217, 4, v216
    v_xor_b32 v17, 0x1000, v13
    s_xor_b32 s88, s60, 2
    s_lshl_b32 s88, s88, 1
    v_add_u32 v217, s88, v213
    v_xor_b32 v217, v217, v214
    v_lshl_add_u32 v14, v217, 4, v216
    v_xor_b32 v18, 0x1000, v14
    s_xor_b32 s88, s60, 3
    s_lshl_b32 s88, s88, 1
    v_add_u32 v217, s88, v213
    v_xor_b32 v217, v217, v214
    v_lshl_add_u32 v15, v217, 4, v216
    v_xor_b32 v19, 0x1000, v15
    v_lshlrev_b32 v29, 2, v215
    v_add_u32 v29, 131584, v29
    v_xor_b32 v30, 0x80, v29
    v_bfe_u32 v217, v1, 2, 2
    v_and_b32 v218, 3, v1
    v_bfe_u32 v219, v1, 4, 1
    v_lshrrev_b32 v220, 1, v218
    v_lshl_add_u32 v220, v219, 1, v220
    v_lshrrev_b32 v221, 1, v217
    v_lshlrev_b32 v221, 2, v221
    v_xor_b32 v220, v220, v221
    v_lshlrev_b32 v220, 4, v220
    v_and_b32 v221, 1, v218
    v_lshl_add_u32 v220, v221, 3, v220
    v_lshl_add_u32 v220, v217, 7, v220
    v_lshl_add_u32 v247, v213, 9, v220
    v_lshl_add_u32 v221, v213, 10, v220
    s_lshl_b32 s88, s61, 6
    v_xor_b32 v221, s88, v221
    s_lshl_b32 s88, s60, 11
    v_add_u32 v20, s88, v221
    v_subrev_u32 v21, s88, v221
    v_add_u32 v21, 2048, v21
    v_add_u32 v22, 65536, v20
    v_add_u32 v23, 65536, v21
    v_add_u32 v24, 131072, v20
    v_add_u32 v25, 131072, v21
    v_lshlrev_b32 v28, 4, v1
    v_cmp_eq_u32 s[16:17], 1, v219
    v_cmp_eq_u32 s[18:19], 1, v213
    v_and_b32 v221, 1, v1
    v_cmp_eq_u32 s[20:21], 1, v221
    v_and_b32 v222, 2, v1
    v_cmp_eq_u32 s[22:23], 2, v222
    v_cmp_eq_u32 vcc, v221, v219
    v_mov_b32 v222, 0x3f803f80
    s_nop 0
    v_cndmask_b32 v40, 0, v222, vcc
    v_cndmask_b32 v41, 0, v222, vcc
    v_cndmask_b32 v42, 0, v222, vcc
    v_cndmask_b32 v43, 0, v222, vcc
    v_mov_b32 v73, 0
    v_mov_b32 v77, 0
    v_mov_b32 v81, 0
    v_mov_b32 v74, 0
    v_mov_b32 v78, 0
    v_mov_b32 v82, 0
    v_mov_b32 v75, 0
    v_mov_b32 v79, 0
    v_mov_b32 v83, 0
    v_mov_b32 v246, 0
    s_mov_b32 s14, 0x3fb8aa3b
    s_mov_b32 s15, 0x3fb8aa3b
    s_mov_b32 s13, 0x358637bd
    s_lshl_b32 s88, s61, 1
    s_add_u32 s88, s88, s60
    s_lshl_b32 s88, s88, 7
    s_add_u32 s88, s88, 131072
    v_lshl_add_u32 v26, v212, 2, s88
    v_xor_b32 v27, 0x80, v26
    v_lshlrev_b32 v221, 4, v213
    s_lshl_b32 s88, s89, 2
    s_add_u32 s88, s88, 132096
    v_add_u32 v32, s88, v221
    v_xor_b32 v33, 0x80, v32
    s_lshl_b32 s88, s56, 2
    s_lshl_b32 s90, s60, 1
    s_add_u32 s88, s88, s90
    s_add_u32 s10, s88, s61
    s_xor_b32 s11, s10, 1
    v_and_b32 v221, 15, v1
    v_lshlrev_b32 v244, 3, v221
    v_lshlrev_b32 v39, 2, v1
    s_lshr_b32 s88, s58, 1
    s_mul_i32 s88, s88, 704
    s_and_b32 s89, s58, 1
    s_lshl_b32 s90, s89, 7
    s_add_u32 s90, s90, s88
    s_add_u32 s6, s90, 256
    s_lshl_b32 s89, s89, 6
    s_sub_u32 s88, s88, s89
    s_add_u32 s88, s88, 576
    s_lshl_b32 s5, s58, 7
    s_add_u32 s90, s5, 2048
    s_cmp_eq_u32 s57, 0
    s_cselect_b32 s5, s90, s5
    s_cselect_b32 s6, s6, s88
    s_lshl_b32 s88, s61, 11
    s_lshl_b32 s95, s58, 12
    s_add_u32 s95, s95, s88
    s_add_u32 s95, s95, 8388608
    s_lshr_b32 s89, s58, 1
    s_mul_i32 s89, s89, 10240
    s_add_u32 s88, s88, s89
    s_lshl_b32 s94, s4, 5
    s_add_u32 s94, s94, s88
    s_lshl_b32 s96, s6, 5
    s_add_u32 s96, s96, s88
    s_and_b32 s88, s101, s61
    s_cmp_eq_u32 s88, 1
    s_cselect_b32 s96, 1073741824, s96
    s_lshl_b32 s88, s63, 7
    s_mul_i32 s97, s59, 360448
    s_add_u32 s97, s97, s88
    s_lshl_b32 s98, s59, 17
    s_add_u32 s98, s98, s88
    s_lshl_b32 s0, s62, 16
    s_add_u32 s0, s0, s88
    s_add_u32 s1, s0, 32768
    s_lshl_b32 s99, s62, 3
    s_add_u32 s99, s99, s59
    s_lshl_b32 s99, s99, 15
    s_cmp_eq_u32 s59, 3
    s_cselect_b32 s100, 1073741824, s99
    s_lshl_b32 s101, s62, 6
    s_lshl_b32 s88, s59, 3
    s_add_u32 s101, s101, s88
    s_lshl_b32 s101, s101, 10
    s_add_u32 s101, s101, 8388608
    s_mul_i32 s91, s59, 8704
    s_add_u32 s91, s91, 10485760
    s_lshl_b32 s2, s62, 2
    s_add_u32 s2, s2, s59
    s_lshl_b32 s2, s2, 7
    s_add_u32 s2, s2, 11534336
    s_lshl_b32 s3, s59, 10
    s_add_u32 s3, s3, 11599872
    s_add_u32 m0, s7, 32768
    s_nop 0
    buffer_load_dwordx4 v2, s[24:27], s66 offen offset:0 lds
    buffer_load_dwordx4 v3, s[24:27], s66 offen offset:1024 lds
    buffer_load_dwordx4 v4, s[24:27], s66 offen offset:2048 lds
    buffer_load_dwordx4 v5, s[24:27], s66 offen offset:3072 lds
    s_waitcnt vmcnt(10)
    s_barrier
    ds_read_b128 a[0:3], v12 offset:0
    ds_read_b128 a[128:131], v16 offset:0
    ds_read_b64_tr_b16 v[60:61], v22 offset:0
    ds_read_b64_tr_b16 v[62:63], v22 offset:512
    ds_read_b128 a[4:7], v13 offset:0
    ds_read_b128 a[132:135], v17 offset:0
    ds_read_b64_tr_b16 v[64:65], v23 offset:0
    ds_read_b64_tr_b16 v[66:67], v23 offset:512
    s_waitcnt lgkmcnt(4)
    s_cmp_eq_u32 s57, 0
    s_cbranch_scc0 L_TYPEB
    v_mfma_f32_16x16x32_bf16 v[56:59], v[40:43], v[60:63], 0
    v_mfma_f32_4x4x4_16b_bf16 v[48:51], a[0:1], a[0:1], 0
    v_mfma_f32_4x4x4_16b_bf16 v[52:55], a[2:3], a[2:3], 0
    v_mfma_f32_16x16x32_bf16 v[44:47], v[40:43], a[0:3], 0
    ds_read_b64_tr_b16 v[68:69], v22 offset:4096
    ds_read_b64_tr_b16 v[70:71], v22 offset:4608
    v_mfma_f32_32x32x16_bf16 v[84:99], a[0:3], v[60:63], 0
    ds_read_b128 a[8:11], v14 offset:0
    s_add_u32 m0, s8, 81920
    s_add_u32 s88, s74, s4
    buffer_load_dwordx4 v6, s[28:31], s88 offen lds
    v_mfma_f32_32x32x16_bf16 v[100:115], a[128:131], v[60:63], 0
    ds_read_b128 a[136:139], v18 offset:0
    buffer_load_dwordx4 v7, s[28:31], s88 offen offset:1024 lds
    s_waitcnt lgkmcnt(4)
    v_mfma_f32_4x4x4_16b_bf16 v[48:51], a[4:5], a[4:5], v[48:51]
    v_mfma_f32_4x4x4_16b_bf16 v[52:55], a[6:7], a[6:7], v[52:55]
    v_mfma_f32_16x16x32_bf16 v[44:47], v[40:43], a[4:7], v[44:47]
    ds_read_b64_tr_b16 v[60:61], v23 offset:4096
    ds_read_b64_tr_b16 v[62:63], v23 offset:4608
    v_mfma_f32_32x32x16_bf16 v[84:99], a[4:7], v[64:67], v[84:99]
    ds_read_b128 a[12:15], v15 offset:0
    s_add_u32 m0, s7, 49152
    s_nop 0
    buffer_load_dwordx4 v2, s[24:27], s67 offen offset:0 lds
    v_mfma_f32_32x32x16_bf16 v[100:115], a[132:135], v[64:67], v[100:115]
    ds_read_b128 a[140:143], v19 offset:0
    buffer_load_dwordx4 v3, s[24:27], s67 offen offset:1024 lds
    s_waitcnt vmcnt(8) lgkmcnt(4)
    s_barrier
    v_mfma_f32_16x16x32_bf16 v[56:59], v[40:43], v[68:71], v[56:59]
    v_mfma_f32_4x4x4_16b_bf16 v[48:51], a[8:9], a[8:9], v[48:51]
    v_mfma_f32_4x4x4_16b_bf16 v[52:55], a[10:11], a[10:11], v[52:55]
    v_mfma_f32_16x16x32_bf16 v[44:47], v[40:43], a[8:11], v[44:47]
    ds_read_b64_tr_b16 v[64:65], v22 offset:8192
    ds_read_b64_tr_b16 v[66:67], v22 offset:8704
    v_mfma_f32_32x32x16_bf16 v[84:99], a[8:11], v[68:71], v[84:99]
    ds_read_b128 a[16:19], v12 offset:16384
    buffer_load_dwordx4 v4, s[24:27], s67 offen offset:2048 lds
    v_mfma_f32_32x32x16_bf16 v[100:115], a[136:139], v[68:71], v[100:115]
    ds_read_b128 a[144:147], v16 offset:16384
    buffer_load_dwordx4 v5, s[24:27], s67 offen offset:3072 lds
    s_waitcnt lgkmcnt(4)
    v_mfma_f32_4x4x4_16b_bf16 v[48:51], a[12:13], a[12:13], v[48:51]
    v_mfma_f32_4x4x4_16b_bf16 v[52:55], a[14:15], a[14:15], v[52:55]
    v_mfma_f32_16x16x32_bf16 v[44:47], v[40:43], a[12:15], v[44:47]
    ds_read_b64_tr_b16 v[68:69], v23 offset:8192
    ds_read_b64_tr_b16 v[70:71], v23 offset:8704
    v_mfma_f32_32x32x16_bf16 v[84:99], a[12:15], v[60:63], v[84:99]
    ds_read_b128 a[20:23], v13 offset:16384
    s_add_u32 m0, s8, 90112
    s_add_u32 s88, s75, s4
    buffer_load_dwordx4 v6, s[28:31], s88 offen lds
    v_mfma_f32_32x32x16_bf16 v[100:115], a[140:143], v[60:63], v[100:115]
    ds_read_b128 a[148:151], v17 offset:16384
    buffer_load_dwordx4 v7, s[28:31], s88 offen offset:1024 lds
    s_waitcnt lgkmcnt(4)
    v_mfma_f32_16x16x32_bf16 v[56:59], v[40:43], v[64:67], v[56:59]
    v_mfma_f32_4x4x4_16b_bf16 v[48:51], a[16:17], a[16:17], v[48:51]
    v_mfma_f32_4x4x4_16b_bf16 v[52:55], a[18:19], a[18:19], v[52:55]
    v_mfma_f32_16x16x32_bf16 v[44:47], v[40:43], a[16:19], v[44:47]
    ds_read_b64_tr_b16 v[60:61], v22 offset:12288
    ds_read_b64_tr_b16 v[62:63], v22 offset:12800
    v_mfma_f32_32x32x16_bf16 v[84:99], a[16:19], v[64:67], v[84:99]
    ds_read_b128 a[24:27], v14 offset:16384
    s_add_u32 m0, s7, 147456
    s_nop 0
    buffer_load_dwordx4 v2, s[24:27], s68 offen offset:0 lds
    v_mfma_f32_32x32x16_bf16 v[100:115], a[144:147], v[64:67], v[100:115]
    ds_read_b128 a[152:155], v18 offset:16384
    buffer_load_dwordx4 v3, s[24:27], s68 offen offset:1024 lds
    s_waitcnt lgkmcnt(4)
    v_mfma_f32_4x4x4_16b_bf16 v[48:51], a[20:21], a[20:21], v[48:51]
    v_mfma_f32_4x4x4_16b_bf16 v[52:55], a[22:23], a[22:23], v[52:55]
    v_mfma_f32_16x16x32_bf16 v[44:47], v[40:43], a[20:23], v[44:47]
    ds_read_b64_tr_b16 v[64:65], v23 offset:12288
    ds_read_b64_tr_b16 v[66:67], v23 offset:12800
    v_mfma_f32_32x32x16_bf16 v[84:99], a[20:23], v[68:71], v[84:99]
    ds_read_b128 a[28:31], v15 offset:16384
    buffer_load_dwordx4 v4, s[24:27], s68 offen offset:2048 lds
    v_mfma_f32_32x32x16_bf16 v[100:115], a[148:151], v[68:71], v[100:115]
    ds_read_b128 a[156:159], v19 offset:16384
    buffer_load_dwordx4 v5, s[24:27], s68 offen offset:3072 lds
    s_waitcnt vmcnt(10) lgkmcnt(4)
    s_barrier
    v_mfma_f32_16x16x32_bf16 v[56:59], v[40:43], v[60:63], v[56:59]
    v_mfma_f32_4x4x4_16b_bf16 v[48:51], a[24:25], a[24:25], v[48:51]
    v_mfma_f32_4x4x4_16b_bf16 v[52:55], a[26:27], a[26:27], v[52:55]
    v_mfma_f32_16x16x32_bf16 v[44:47], v[40:43], a[24:27], v[44:47]
    ds_read_b64_tr_b16 v[68:69], v22 offset:16384
    ds_read_b64_tr_b16 v[70:71], v22 offset:16896
    v_mfma_f32_32x32x16_bf16 v[84:99], a[24:27], v[60:63], v[84:99]
    ds_read_b128 a[32:35], v12 offset:32768
    s_add_u32 m0, s8, 98304
    s_add_u32 s88, s76, s4
    buffer_load_dwordx4 v6, s[28:31], s88 offen lds
    v_mfma_f32_32x32x16_bf16 v[100:115], a[152:155], v[60:63], v[100:115]
    ds_read_b128 a[160:163], v16 offset:32768
    buffer_load_dwordx4 v7, s[28:31], s88 offen offset:1024 lds
    s_waitcnt lgkmcnt(4)
    v_mfma_f32_4x4x4_16b_bf16 v[48:51], a[28:29], a[28:29], v[48:51]
    v_mfma_f32_4x4x4_16b_bf16 v[52:55], a[30:31], a[30:31], v[52:55]
    v_mfma_f32_16x16x32_bf16 v[44:47], v[40:43], a[28:31], v[44:47]
    ds_read_b64_tr_b16 v[60:61], v23 offset:16384
    ds_read_b64_tr_b16 v[62:63], v23 offset:16896
    v_mfma_f32_32x32x16_bf16 v[84:99], a[28:31], v[64:67], v[84:99]
    ds_read_b128 a[36:39], v13 offset:32768
    s_add_u32 m0, s7, 0
    s_nop 0
    buffer_load_dwordx4 v2, s[24:27], s69 offen offset:0 lds
    v_mfma_f32_32x32x16_bf16 v[100:115], a[156:159], v[64:67], v[100:115]
    ds_read_b128 a[164:167], v17 offset:32768
    buffer_load_dwordx4 v3, s[24:27], s69 offen offset:1024 lds
    s_waitcnt lgkmcnt(4)
    v_mfma_f32_16x16x32_bf16 v[56:59], v[40:43], v[68:71], v[56:59]
    v_mfma_f32_4x4x4_16b_bf16 v[48:51], a[32:33], a[32:33], v[48:51]
    v_mfma_f32_4x4x4_16b_bf16 v[52:55], a[34:35], a[34:35], v[52:55]
    v_mfma_f32_16x16x32_bf16 v[44:47], v[40:43], a[32:35], v[44:47]
    ds_read_b64_tr_b16 v[64:65], v22 offset:20480
    ds_read_b64_tr_b16 v[66:67], v22 offset:20992
    v_mfma_f32_32x32x16_bf16 v[84:99], a[32:35], v[68:71], v[84:99]
    ds_read_b128 a[40:43], v14 offset:32768
    buffer_load_dwordx4 v4, s[24:27], s69 offen offset:2048 lds
    v_mfma_f32_32x32x16_bf16 v[100:115], a[160:163], v[68:71], v[100:115]
    ds_read_b128 a[168:171], v18 offset:32768
    buffer_load_dwordx4 v5, s[24:27], s69 offen offset:3072 lds
    s_waitcnt lgkmcnt(4)
    v_mfma_f32_4x4x4_16b_bf16 v[48:51], a[36:37], a[36:37], v[48:51]
    v_mfma_f32_4x4x4_16b_bf16 v[52:55], a[38:39], a[38:39], v[52:55]
    v_mfma_f32_16x16x32_bf16 v[44:47], v[40:43], a[36:39], v[44:47]
    ds_read_b64_tr_b16 v[68:69], v23 offset:20480
    ds_read_b64_tr_b16 v[70:71], v23 offset:20992
    v_mfma_f32_32x32x16_bf16 v[84:99], a[36:39], v[60:63], v[84:99]
    ds_read_b128 a[44:47], v15 offset:32768
    s_add_u32 m0, s8, 106496
    s_add_u32 s88, s77, s4
    buffer_load_dwordx4 v6, s[28:31], s88 offen lds
    v_mfma_f32_32x32x16_bf16 v[100:115], a[164:167], v[60:63], v[100:115]
    ds_read_b128 a[172:175], v19 offset:32768
    buffer_load_dwordx4 v7, s[28:31], s88 offen offset:1024 lds
    s_waitcnt vmcnt(12) lgkmcnt(4)
    s_barrier
    s_cmp_eq_u32 s12, 1
    s_cbranch_scc0 L_NOZF
    s_lshl_b32 s89, s58, 2
    v_mov_b32 v37, 1
    s_mov_b64 exec, 1
    buffer_store_dword v37, v246, s[40:43], s89 offen sc1
    s_mov_b64 exec, -1
L_NOZF:
    v_mfma_f32_16x16x32_bf16 v[56:59], v[40:43], v[64:67], v[56:59]
    v_mfma_f32_4x4x4_16b_bf16 v[48:51], a[40:41], a[40:41], v[48:51]
    v_mfma_f32_4x4x4_16b_bf16 v[52:55], a[42:43], a[42:43], v[52:55]
    v_mfma_f32_16x16x32_bf16 v[44:47], v[40:43], a[40:43], v[44:47]
    ds_read_b64_tr_b16 v[60:61], v22 offset:24576
    ds_read_b64_tr_b16 v[62:63], v22 offset:25088
    v_mfma_f32_32x32x16_bf16 v[84:99], a[40:43], v[64:67], v[84:99]
    ds_read_b128 a[48:51], v12 offset:49152
    s_add_u32 m0, s7, 16384
    s_nop 0
    buffer_load_dwordx4 v2, s[24:27], s70 offen offset:0 lds
    v_mfma_f32_32x32x16_bf16 v[100:115], a[168:171], v[64:67], v[100:115]
    ds_read_b128 a[176:179], v16 offset:49152
    buffer_load_dwordx4 v3, s[24:27], s70 offen offset:1024 lds
    s_waitcnt lgkmcnt(4)
    v_mfma_f32_4x4x4_16b_bf16 v[48:51], a[44:45], a[44:45], v[48:51]
    v_mfma_f32_4x4x4_16b_bf16 v[52:55], a[46:47], a[46:47], v[52:55]
    v_mfma_f32_16x16x32_bf16 v[44:47], v[40:43], a[44:47], v[44:47]
    ds_read_b64_tr_b16 v[64:65], v23 offset:24576
    ds_read_b64_tr_b16 v[66:67], v23 offset:25088
    v_mfma_f32_32x32x16_bf16 v[84:99], a[44:47], v[68:71], v[84:99]
    ds_read_b128 a[52:55], v13 offset:49152
    buffer_load_dwordx4 v4, s[24:27], s70 offen offset:2048 lds
    v_mfma_f32_32x32x16_bf16 v[100:115], a[172:175], v[68:71], v[100:115]
    ds_read_b128 a[180:183], v17 offset:49152
    buffer_load_dwordx4 v5, s[24:27], s70 offen offset:3072 lds
    s_waitcnt lgkmcnt(4)
    v_mfma_f32_16x16x32_bf16 v[56:59], v[40:43], v[60:63], v[56:59]
    v_mfma_f32_4x4x4_16b_bf16 v[48:51], a[48:49], a[48:49], v[48:51]
    v_mfma_f32_4x4x4_16b_bf16 v[52:55], a[50:51], a[50:51], v[52:55]
    v_mfma_f32_16x16x32_bf16 v[44:47], v[40:43], a[48:51], v[44:47]
    ds_read_b64_tr_b16 v[68:69], v22 offset:28672
    ds_read_b64_tr_b16 v[70:71], v22 offset:29184
    v_mfma_f32_32x32x16_bf16 v[84:99], a[48:51], v[60:63], v[84:99]
    ds_read_b128 a[56:59], v14 offset:49152
    s_add_u32 m0, s8, 114688
    s_add_u32 s88, s78, s4
    buffer_load_dwordx4 v6, s[28:31], s88 offen lds
    v_mfma_f32_32x32x16_bf16 v[100:115], a[176:179], v[60:63], v[100:115]
    ds_read_b128 a[184:187], v18 offset:49152
    buffer_load_dwordx4 v7, s[28:31], s88 offen offset:1024 lds
    s_waitcnt lgkmcnt(4)
    v_mfma_f32_4x4x4_16b_bf16 v[48:51], a[52:53], a[52:53], v[48:51]
    v_mfma_f32_4x4x4_16b_bf16 v[52:55], a[54:55], a[54:55], v[52:55]
    v_mfma_f32_16x16x32_bf16 v[44:47], v[40:43], a[52:55], v[44:47]
    ds_read_b64_tr_b16 v[60:61], v23 offset:28672
    ds_read_b64_tr_b16 v[62:63], v23 offset:29184
    v_mfma_f32_32x32x16_bf16 v[84:99], a[52:55], v[64:67], v[84:99]
    ds_read_b128 a[60:63], v15 offset:49152
    v_mfma_f32_32x32x16_bf16 v[100:115], a[180:183], v[64:67], v[100:115]
    ds_read_b128 a[188:191], v19 offset:49152
    s_waitcnt vmcnt(12) lgkmcnt(4)
    s_barrier
    v_mfma_f32_16x16x32_bf16 v[56:59], v[40:43], v[68:71], v[56:59]
    v_mfma_f32_4x4x4_16b_bf16 v[48:51], a[56:57], a[56:57], v[48:51]
    v_mfma_f32_4x4x4_16b_bf16 v[52:55], a[58:59], a[58:59], v[52:55]
    v_mfma_f32_16x16x32_bf16 v[44:47], v[40:43], a[56:59], v[44:47]
    ds_read_b64_tr_b16 v[64:65], v22 offset:32768
    ds_read_b64_tr_b16 v[66:67], v22 offset:33280
    v_mfma_f32_32x32x16_bf16 v[84:99], a[56:59], v[68:71], v[84:99]
    v_add_u32 v37, 147456, v12
    ds_read_b128 a[64:67], v37
    s_add_u32 m0, s7, 32768
    s_nop 0
    buffer_load_dwordx4 v2, s[24:27], s71 offen offset:0 lds
    v_mfma_f32_32x32x16_bf16 v[100:115], a[184:187], v[68:71], v[100:115]
    v_add_u32 v37, 147456, v16
    ds_read_b128 a[192:195], v37
    buffer_load_dwordx4 v3, s[24:27], s71 offen offset:1024 lds
    s_waitcnt lgkmcnt(4)
    v_mfma_f32_4x4x4_16b_bf16 v[48:51], a[60:61], a[60:61], v[48:51]
    v_mfma_f32_4x4x4_16b_bf16 v[52:55], a[62:63], a[62:63], v[52:55]
    v_mfma_f32_16x16x32_bf16 v[44:47], v[40:43], a[60:63], v[44:47]
    ds_read_b64_tr_b16 v[68:69], v23 offset:32768
    ds_read_b64_tr_b16 v[70:71], v23 offset:33280
    v_mfma_f32_32x32x16_bf16 v[84:99], a[60:63], v[60:63], v[84:99]
    v_add_u32 v37, 147456, v13
    ds_read_b128 a[68:71], v37
    buffer_load_dwordx4 v4, s[24:27], s71 offen offset:2048 lds
    v_mfma_f32_32x32x16_bf16 v[100:115], a[188:191], v[60:63], v[100:115]
    v_add_u32 v37, 147456, v17
    ds_read_b128 a[196:199], v37
    buffer_load_dwordx4 v5, s[24:27], s71 offen offset:3072 lds
    s_waitcnt lgkmcnt(4)
    v_mfma_f32_16x16x32_bf16 v[56:59], v[40:43], v[64:67], v[56:59]
    v_mfma_f32_4x4x4_16b_bf16 v[48:51], a[64:65], a[64:65], v[48:51]
    v_mfma_f32_4x4x4_16b_bf16 v[52:55], a[66:67], a[66:67], v[52:55]
    v_mfma_f32_16x16x32_bf16 v[44:47], v[40:43], a[64:67], v[44:47]
    ds_read_b64_tr_b16 v[60:61], v22 offset:36864
    ds_read_b64_tr_b16 v[62:63], v22 offset:37376
    v_mfma_f32_32x32x16_bf16 v[84:99], a[64:67], v[64:67], v[84:99]
    v_add_u32 v37, 147456, v14
    ds_read_b128 a[72:75], v37
    s_add_u32 m0, s8, 122880
    s_add_u32 s88, s79, s4
    buffer_load_dwordx4 v6, s[28:31], s88 offen lds
    v_mfma_f32_32x32x16_bf16 v[100:115], a[192:195], v[64:67], v[100:115]
    v_add_u32 v37, 147456, v18
    ds_read_b128 a[200:203], v37
    buffer_load_dwordx4 v7, s[28:31], s88 offen offset:1024 lds
    s_waitcnt lgkmcnt(4)
    v_mfma_f32_4x4x4_16b_bf16 v[48:51], a[68:69], a[68:69], v[48:51]
    v_mfma_f32_4x4x4_16b_bf16 v[52:55], a[70:71], a[70:71], v[52:55]
    v_mfma_f32_16x16x32_bf16 v[44:47], v[40:43], a[68:71], v[44:47]
    ds_read_b64_tr_b16 v[64:65], v23 offset:36864
    ds_read_b64_tr_b16 v[66:67], v23 offset:37376
    v_mfma_f32_32x32x16_bf16 v[84:99], a[68:71], v[68:71], v[84:99]
    v_add_u32 v37, 147456, v15
    ds_read_b128 a[76:79], v37
    v_mfma_f32_32x32x16_bf16 v[100:115], a[196:199], v[68:71], v[100:115]
    v_add_u32 v37, 147456, v19
    ds_read_b128 a[204:207], v37
    s_add_u32 m0, s8, 65536
    s_add_u32 s88, s72, s5
    buffer_load_dwordx4 v6, s[28:31], s88 offen lds
    s_waitcnt vmcnt(13) lgkmcnt(4)
    s_barrier
    v_mfma_f32_16x16x32_bf16 v[56:59], v[40:43], v[60:63], v[56:59]
    v_mfma_f32_4x4x4_16b_bf16 v[48:51], a[72:73], a[72:73], v[48:51]
    v_mfma_f32_4x4x4_16b_bf16 v[52:55], a[74:75], a[74:75], v[52:55]
    v_mfma_f32_16x16x32_bf16 v[44:47], v[40:43], a[72:75], v[44:47]
    ds_read_b64_tr_b16 v[68:69], v22 offset:40960
    ds_read_b64_tr_b16 v[70:71], v22 offset:41472
    v_mfma_f32_32x32x16_bf16 v[84:99], a[72:75], v[60:63], v[84:99]
    ds_read_b128 a[80:83], v12 offset:0
    buffer_load_dwordx4 v7, s[28:31], s88 offen offset:1024 lds
    v_mfma_f32_32x32x16_bf16 v[100:115], a[200:203], v[60:63], v[100:115]
    ds_read_b128 a[208:211], v16 offset:0
    s_add_u32 m0, s8, 73728
    s_add_u32 s88, s73, s5
    buffer_load_dwordx4 v6, s[28:31], s88 offen lds
    s_waitcnt lgkmcnt(4)
    v_mfma_f32_4x4x4_16b_bf16 v[48:51], a[76:77], a[76:77], v[48:51]
    v_mfma_f32_4x4x4_16b_bf16 v[52:55], a[78:79], a[78:79], v[52:55]
    v_mfma_f32_16x16x32_bf16 v[44:47], v[40:43], a[76:79], v[44:47]
    ds_read_b64_tr_b16 v[60:61], v23 offset:40960
    ds_read_b64_tr_b16 v[62:63], v23 offset:41472
    v_mfma_f32_32x32x16_bf16 v[84:99], a[76:79], v[64:67], v[84:99]
    ds_read_b128 a[84:87], v13 offset:0
    buffer_load_dwordx4 v7, s[28:31], s88 offen offset:1024 lds
    v_mfma_f32_32x32x16_bf16 v[100:115], a[204:207], v[64:67], v[100:115]
    ds_read_b128 a[212:215], v17 offset:0
    s_waitcnt lgkmcnt(4)
    v_mfma_f32_16x16x32_bf16 v[56:59], v[40:43], v[68:71], v[56:59]
    v_mfma_f32_4x4x4_16b_bf16 v[48:51], a[80:81], a[80:81], v[48:51]
    v_mfma_f32_4x4x4_16b_bf16 v[52:55], a[82:83], a[82:83], v[52:55]
    v_mfma_f32_16x16x32_bf16 v[44:47], v[40:43], a[80:83], v[44:47]
    ds_read_b64_tr_b16 v[64:65], v22 offset:45056
    ds_read_b64_tr_b16 v[66:67], v22 offset:45568
    v_mfma_f32_32x32x16_bf16 v[84:99], a[80:83], v[68:71], v[84:99]
    ds_read_b128 a[88:91], v14 offset:0
    s_add_u32 m0, s8, 81920
    s_add_u32 s88, s80, s6
    buffer_load_dwordx4 v8, s[32:35], s88 offen lds
    v_mfma_f32_32x32x16_bf16 v[100:115], a[208:211], v[68:71], v[100:115]
    ds_read_b128 a[216:219], v18 offset:0
    buffer_load_dwordx4 v9, s[32:35], s88 offen offset:1024 lds
    s_waitcnt lgkmcnt(4)
    v_mfma_f32_4x4x4_16b_bf16 v[48:51], a[84:85], a[84:85], v[48:51]
    v_mfma_f32_4x4x4_16b_bf16 v[52:55], a[86:87], a[86:87], v[52:55]
    v_mfma_f32_16x16x32_bf16 v[44:47], v[40:43], a[84:87], v[44:47]
    ds_read_b64_tr_b16 v[68:69], v23 offset:45056
    ds_read_b64_tr_b16 v[70:71], v23 offset:45568
    v_mfma_f32_32x32x16_bf16 v[84:99], a[84:87], v[60:63], v[84:99]
    ds_read_b128 a[92:95], v15 offset:0
    v_mfma_f32_32x32x16_bf16 v[100:115], a[212:215], v[60:63], v[100:115]
    ds_read_b128 a[220:223], v19 offset:0
    s_add_u32 m0, s8, 49152
    s_add_u32 s88, s81, s6
    buffer_load_dwordx4 v8, s[32:35], s88 offen lds
    s_waitcnt vmcnt(13) lgkmcnt(4)
    s_barrier
    buffer_load_dword v245, v39, s[40:43], 0 offen sc1
    v_mfma_f32_16x16x32_bf16 v[56:59], v[40:43], v[64:67], v[56:59]
    v_mfma_f32_4x4x4_16b_bf16 v[48:51], a[88:89], a[88:89], v[48:51]
    v_mfma_f32_4x4x4_16b_bf16 v[52:55], a[90:91], a[90:91], v[52:55]
    v_mfma_f32_16x16x32_bf16 v[44:47], v[40:43], a[88:91], v[44:47]
    ds_read_b64_tr_b16 v[60:61], v22 offset:49152
    ds_read_b64_tr_b16 v[62:63], v22 offset:49664
    v_mfma_f32_32x32x16_bf16 v[84:99], a[88:91], v[64:67], v[84:99]
    ds_read_b128 a[96:99], v12 offset:16384
    buffer_load_dwordx4 v9, s[32:35], s88 offen offset:1024 lds
    v_mfma_f32_32x32x16_bf16 v[100:115], a[216:219], v[64:67], v[100:115]
    ds_read_b128 a[224:227], v16 offset:16384
    s_waitcnt lgkmcnt(4)
    v_mfma_f32_4x4x4_16b_bf16 v[48:51], a[92:93], a[92:93], v[48:51]
    v_mfma_f32_4x4x4_16b_bf16 v[52:55], a[94:95], a[94:95], v[52:55]
    v_mfma_f32_16x16x32_bf16 v[44:47], v[40:43], a[92:95], v[44:47]
    ds_read_b64_tr_b16 v[64:65], v23 offset:49152
    ds_read_b64_tr_b16 v[66:67], v23 offset:49664
    v_mfma_f32_32x32x16_bf16 v[84:99], a[92:95], v[68:71], v[84:99]
    ds_read_b128 a[100:103], v13 offset:16384
    v_mfma_f32_32x32x16_bf16 v[100:115], a[220:223], v[68:71], v[100:115]
    ds_read_b128 a[228:231], v17 offset:16384
    s_waitcnt lgkmcnt(4)
    v_mfma_f32_16x16x32_bf16 v[56:59], v[40:43], v[60:63], v[56:59]
    v_mfma_f32_4x4x4_16b_bf16 v[48:51], a[96:97], a[96:97], v[48:51]
    v_mfma_f32_4x4x4_16b_bf16 v[52:55], a[98:99], a[98:99], v[52:55]
    v_mfma_f32_16x16x32_bf16 v[44:47], v[40:43], a[96:99], v[44:47]
    ds_read_b64_tr_b16 v[68:69], v22 offset:53248
    ds_read_b64_tr_b16 v[70:71], v22 offset:53760
    v_mfma_f32_32x32x16_bf16 v[84:99], a[96:99], v[60:63], v[84:99]
    ds_read_b128 a[104:107], v14 offset:16384
    v_mfma_f32_32x32x16_bf16 v[100:115], a[224:227], v[60:63], v[100:115]
    ds_read_b128 a[232:235], v18 offset:16384
    s_waitcnt lgkmcnt(4)
    v_mfma_f32_4x4x4_16b_bf16 v[48:51], a[100:101], a[100:101], v[48:51]
    v_mfma_f32_4x4x4_16b_bf16 v[52:55], a[102:103], a[102:103], v[52:55]
    v_mfma_f32_16x16x32_bf16 v[44:47], v[40:43], a[100:103], v[44:47]
    ds_read_b64_tr_b16 v[60:61], v23 offset:53248
    ds_read_b64_tr_b16 v[62:63], v23 offset:53760
    v_mfma_f32_32x32x16_bf16 v[84:99], a[100:103], v[64:67], v[84:99]
    ds_read_b128 a[108:111], v15 offset:16384
    v_mfma_f32_32x32x16_bf16 v[100:115], a[228:231], v[64:67], v[100:115]
    ds_read_b128 a[236:239], v19 offset:16384
    s_waitcnt vmcnt(9) lgkmcnt(4)
    s_barrier
    s_and_b32 s65, s62, 3
    s_lshl_b32 s65, s65, 1
    s_add_u32 s65, s65, s63
    s_and_b32 s65, s65, 7
    s_lshl_b32 s12, s65, 14
    s_lshl_b32 s64, s65, 10
    s_or_b32 s101, s101, s64
    s_or_b32 s64, s64, s99
    v_mfma_f32_16x16x32_bf16 v[56:59], v[40:43], v[68:71], v[56:59]
    v_mfma_f32_4x4x4_16b_bf16 v[48:51], a[104:105], a[104:105], v[48:51]
    v_mfma_f32_4x4x4_16b_bf16 v[52:55], a[106:107], a[106:107], v[52:55]
    v_mfma_f32_16x16x32_bf16 v[44:47], v[40:43], a[104:107], v[44:47]
    ds_read_b64_tr_b16 v[64:65], v22 offset:57344
    ds_read_b64_tr_b16 v[66:67], v22 offset:57856
    v_mfma_f32_32x32x16_bf16 v[84:99], a[104:107], v[68:71], v[84:99]
    ds_read_b128 a[112:115], v12 offset:32768
    v_mfma_f32_32x32x16_bf16 v[100:115], a[232:235], v[68:71], v[100:115]
    ds_read_b128 a[240:243], v16 offset:32768
    s_waitcnt lgkmcnt(4)
    v_mfma_f32_4x4x4_16b_bf16 v[48:51], a[108:109], a[108:109], v[48:51]
    v_mfma_f32_4x4x4_16b_bf16 v[52:55], a[110:111], a[110:111], v[52:55]
    v_mfma_f32_16x16x32_bf16 v[44:47], v[40:43], a[108:111], v[44:47]
    ds_read_b64_tr_b16 v[68:69], v23 offset:57344
    ds_read_b64_tr_b16 v[70:71], v23 offset:57856
    v_mfma_f32_32x32x16_bf16 v[84:99], a[108:111], v[60:63], v[84:99]
    ds_read_b128 a[116:119], v13 offset:32768
    v_mfma_f32_32x32x16_bf16 v[100:115], a[236:239], v[60:63], v[100:115]
    ds_read_b128 a[244:247], v17 offset:32768
    v_cndmask_b32 v37, v56, v57, s[16:17]
    ds_write_b32 v26, v37
    s_waitcnt lgkmcnt(5)
    v_mfma_f32_16x16x32_bf16 v[56:59], v[40:43], v[64:67], v[56:59]
    v_mfma_f32_4x4x4_16b_bf16 v[48:51], a[112:113], a[112:113], v[48:51]
    v_mfma_f32_4x4x4_16b_bf16 v[52:55], a[114:115], a[114:115], v[52:55]
    v_mfma_f32_16x16x32_bf16 v[44:47], v[40:43], a[112:115], v[44:47]
    ds_read_b64_tr_b16 v[60:61], v22 offset:61440
    ds_read_b64_tr_b16 v[62:63], v22 offset:61952
    v_mfma_f32_32x32x16_bf16 v[84:99], a[112:115], v[64:67], v[84:99]
    ds_read_b128 a[120:123], v14 offset:32768
    v_mfma_f32_32x32x16_bf16 v[100:115], a[240:243], v[64:67], v[100:115]
    ds_read_b128 a[248:251], v18 offset:32768
    s_waitcnt lgkmcnt(5)
    v_mfma_f32_16x16x32_bf16 v[56:59], v[40:43], v[68:71], v[56:59]
    v_mfma_f32_4x4x4_16b_bf16 v[48:51], a[116:117], a[116:117], v[48:51]
    v_mfma_f32_4x4x4_16b_bf16 v[52:55], a[118:119], a[118:119], v[52:55]
    v_mfma_f32_16x16x32_bf16 v[44:47], v[40:43], a[116:119], v[44:47]
    ds_read_b64_tr_b16 v[64:65], v23 offset:61440
    ds_read_b64_tr_b16 v[66:67], v23 offset:61952
    v_mfma_f32_32x32x16_bf16 v[84:99], a[116:119], v[68:71], v[84:99]
    ds_read_b128 a[124:127], v15 offset:32768
    v_mfma_f32_32x32x16_bf16 v[100:115], a[244:247], v[68:71], v[100:115]
    ds_read_b128 a[252:255], v19 offset:32768
    s_waitcnt vmcnt(7) lgkmcnt(4)
    s_barrier
    v_mfma_f32_16x16x32_bf16 v[56:59], v[40:43], v[60:63], v[56:59]
    v_mfma_f32_4x4x4_16b_bf16 v[48:51], a[120:121], a[120:121], v[48:51]
    v_mfma_f32_4x4x4_16b_bf16 v[52:55], a[122:123], a[122:123], v[52:55]
    v_mfma_f32_16x16x32_bf16 v[44:47], v[40:43], a[120:123], v[44:47]
    ds_read_b64_tr_b16 v[68:69], v22 offset:0
    ds_read_b64_tr_b16 v[70:71], v22 offset:512
    v_mfma_f32_32x32x16_bf16 v[84:99], a[120:123], v[60:63], v[84:99]
    s_add_u32 m0, s8, 57344
    s_add_u32 s88, s74, s5
    buffer_load_dwordx4 v6, s[28:31], s88 offen lds
    v_mfma_f32_32x32x16_bf16 v[100:115], a[248:251], v[60:63], v[100:115]
    ds_read_b32 v36, v27
    buffer_load_dwordx4 v7, s[28:31], s88 offen offset:1024 lds
    s_waitcnt lgkmcnt(3)
    v_mfma_f32_16x16x32_bf16 v[56:59], v[40:43], v[64:67], v[56:59]
    v_mfma_f32_4x4x4_16b_bf16 v[48:51], a[124:125], a[124:125], v[48:51]
    v_mfma_f32_4x4x4_16b_bf16 v[52:55], a[126:127], a[126:127], v[52:55]
    v_mfma_f32_16x16x32_bf16 v[44:47], v[40:43], a[124:127], v[44:47]
    ds_read_b64_tr_b16 v[60:61], v23 offset:0
    ds_read_b64_tr_b16 v[62:63], v23 offset:512
    v_mfma_f32_32x32x16_bf16 v[84:99], a[124:127], v[64:67], v[84:99]
    s_add_u32 m0, s8, 90112
    s_add_u32 s88, s75, s5
    buffer_load_dwordx4 v6, s[28:31], s88 offen lds
    v_mfma_f32_32x32x16_bf16 v[100:115], a[252:255], v[64:67], v[100:115]
    buffer_load_dwordx4 v7, s[28:31], s88 offen offset:1024 lds
    s_waitcnt lgkmcnt(3)
    s_waitcnt lgkmcnt(2)
    v_cndmask_b32 v38, v56, v57, s[16:17]
    v_mfma_f32_16x16x32_bf16 v[56:59], v[40:43], v[68:71], 0
    v_mfma_f32_32x32x16_bf16 v[116:131], a[0:3], v[68:71], 0
    ds_read_b64_tr_b16 v[64:65], v22 offset:4096
    ds_read_b64_tr_b16 v[66:67], v22 offset:4608
    s_add_u32 m0, s8, 98304
    s_add_u32 s88, s76, s5
    buffer_load_dwordx4 v6, s[28:31], s88 offen lds
    v_mfma_f32_32x32x16_bf16 v[132:147], a[128:131], v[68:71], 0
    buffer_load_dwordx4 v7, s[28:31], s88 offen offset:1024 lds
    s_waitcnt lgkmcnt(2)
    v_cndmask_b32 v213, v44, v45, s[16:17]
    v_add_f32 v48, v48, v52
    v_add_f32 v49, v49, v53
    v_mfma_f32_32x32x16_bf16 v[116:131], a[4:7], v[60:63], v[116:131]
    ds_read_b64_tr_b16 v[68:69], v23 offset:4096
    ds_read_b64_tr_b16 v[70:71], v23 offset:4608
    v_add_f32 v50, v50, v54
    v_add_f32 v51, v51, v55
    v_cndmask_b32 v214, v48, v49, s[20:21]
    v_cndmask_b32 v215, v50, v51, s[20:21]
    v_mfma_f32_32x32x16_bf16 v[132:147], a[132:135], v[60:63], v[132:147]
    s_waitcnt vmcnt(11) lgkmcnt(2)
    s_barrier
    v_cndmask_b32 v214, v214, v215, s[22:23]
    v_mov_b32 v215, v214
    v_mul_f32 v213, 0x3b000000, v213
    v_cvt_pk_bf16_f32 v72, v213, v213
    v_mfma_f32_16x16x32_bf16 v[56:59], v[40:43], v[64:67], v[56:59]
    v_mfma_f32_32x32x16_bf16 v[116:131], a[8:11], v[64:67], v[116:131]
    ds_read_b64_tr_b16 v[60:61], v22 offset:8192
    ds_read_b64_tr_b16 v[62:63], v22 offset:8704
    s_lshl_b32 s9, s62, 3
    s_add_u32 s9, s9, s63
    s_mul_i32 s9, s9, 5504
    s_cmp_eq_u32 s59, 0
    s_cselect_b32 s9, s9, 1073741824
    v_lshlrev_b32 v252, 7, v1
    s_mov_b32 exec_lo, 0xffffffff
    s_mov_b32 exec_hi, 0x7ff
    buffer_load_dword v253, v252, s[44:47], s9 offen
    s_mov_b64 exec, -1
    v_mfma_f32_32x32x16_bf16 v[132:147], a[136:139], v[64:67], v[132:147]
    s_waitcnt lgkmcnt(2)
    v_permlane32_swap_b32 v214, v215
    v_add_f32 v214, v214, v215
    v_mul_f32 v214, 0x3b000000, v214
    v_fma_f32 v214, -v213, v213, v214
    v_mfma_f32_32x32x16_bf16 v[116:131], a[12:15], v[68:71], v[116:131]
    ds_read_b64_tr_b16 v[64:65], v23 offset:8192
    ds_read_b64_tr_b16 v[66:67], v23 offset:8704
    s_lshl_b32 s9, s62, 3
    s_add_u32 s9, s9, s63
    s_mul_i32 s9, s9, 2048
    s_cmp_eq_u32 s59, 1
    s_cselect_b32 s9, s9, 1073741824
    v_lshlrev_b32 v252, 7, v1
    s_mov_b32 exec_lo, 0xffff
    s_mov_b32 exec_hi, 0x0
    buffer_load_dword v253, v252, s[48:51], s9 offen
    s_mov_b64 exec, -1
    v_mfma_f32_32x32x16_bf16 v[132:147], a[140:143], v[68:71], v[132:147]
    s_waitcnt lgkmcnt(2)
    v_max_f32 v214, 0, v214
    v_cvt_pk_bf16_f32 v214, v214, v214
    v_and_b32 v214, 0xffff0000, v214
    v_add_f32 v214, 0x3727c5ac, v214
    v_mfma_f32_16x16x32_bf16 v[56:59], v[40:43], v[60:63], v[56:59]
    v_mfma_f32_32x32x16_bf16 v[116:131], a[16:19], v[60:63], v[116:131]
    ds_read_b64_tr_b16 v[68:69], v22 offset:12288
    ds_read_b64_tr_b16 v[70:71], v22 offset:12800
    s_and_b32 s9, s62, 3
    s_lshl_b32 s9, s9, 3
    s_add_u32 s9, s9, s63
    s_mul_i32 s9, s9, 44032
    s_cmp_eq_u32 s59, 2
    s_cselect_b32 s9, s9, 1073741824
    v_lshlrev_b32 v252, 10, v1
    s_mov_b32 exec_lo, 0xffffffff
    s_mov_b32 exec_hi, 0x7ff
    buffer_load_dword v253, v252, s[44:47], s9 offen offset:384
    s_mov_b64 exec, -1
    v_mfma_f32_32x32x16_bf16 v[132:147], a[144:147], v[60:63], v[132:147]
    s_waitcnt lgkmcnt(2)
    v_cvt_pk_bf16_f32 v214, v214, v214
    v_and_b32 v214, 0xffff0000, v214
    v_sqrt_f32 v214, v214
    v_mfma_f32_32x32x16_bf16 v[116:131], a[20:23], v[64:67], v[116:131]
    ds_read_b64_tr_b16 v[60:61], v23 offset:12288
    ds_read_b64_tr_b16 v[62:63], v23 offset:12800
    s_and_b32 s9, s62, 3
    s_lshl_b32 s9, s9, 3
    s_add_u32 s9, s9, s63
    s_mul_i32 s9, s9, 16384
    s_cmp_eq_u32 s59, 3
    s_cselect_b32 s9, s9, 1073741824
    v_lshlrev_b32 v252, 10, v1
    s_mov_b32 exec_lo, 0xffff
    s_mov_b32 exec_hi, 0x0
    buffer_load_dword v253, v252, s[48:51], s9 offen offset:384
    s_mov_b64 exec, -1
    v_mfma_f32_32x32x16_bf16 v[132:147], a[148:151], v[64:67], v[132:147]
    s_waitcnt vmcnt(8) lgkmcnt(2)
    s_barrier
    s_mov_b32 s90, 0
    v_readlane_b32 s92, v245, 16
    v_readlane_b32 s93, v245, 17
    v_readlane_b32 vcc_lo, v245, s58
    s_nop 1
    s_min_u32 vcc_lo, vcc_lo, s92
    s_cmp_lg_u32 vcc_lo, 0
    s_cbranch_scc1 L_POK0
L_PL0:
    s_sleep 2
    buffer_load_dword v245, v39, s[40:43], 0 offen sc1
    s_waitcnt vmcnt(0)
    s_add_u32 s90, s90, 1
    s_cmp_gt_u32 s90, 200000
    s_cbranch_scc1 L_POK0
    v_readlane_b32 s92, v245, 16
    v_readlane_b32 s93, v245, 17
    v_readlane_b32 vcc_lo, v245, s58
    s_nop 1
    s_min_u32 vcc_lo, vcc_lo, s92
    s_cmp_lg_u32 vcc_lo, 0
    s_cbranch_scc0 L_PL0
L_POK0:
    s_nop 4
    v_mov_b32 v250, s92
    v_mov_b32 v251, s93
    ds_write_b32 v29, v72
    v_cvt_pk_bf16_f32 v214, v214, v214
    v_and_b32 v214, 0xffff0000, v214
    v_mfma_f32_16x16x32_bf16 v[56:59], v[40:43], v[68:71], v[56:59]
    v_mfma_f32_32x32x16_bf16 v[116:131], a[24:27], v[68:71], v[116:131]
    ds_read_b64_tr_b16 v[64:65], v20 offset:57344
    ds_read_b64_tr_b16 v[66:67], v20 offset:57856
    s_add_u32 m0, s8, 147456
    s_add_u32 s88, s77, s5
    buffer_load_dwordx4 v6, s[28:31], s88 offen lds
    v_mfma_f32_32x32x16_bf16 v[132:147], a[152:155], v[68:71], v[132:147]
    buffer_load_dwordx4 v7, s[28:31], s88 offen offset:1024 lds
    s_waitcnt lgkmcnt(3)
    v_rcp_f32 v34, v214
    v_add_f32 v38, v38, v36
    v_mfma_f32_32x32x16_bf16 v[116:131], a[28:31], v[60:63], v[116:131]
    ds_read_b64_tr_b16 v[68:69], v21 offset:57344
    ds_read_b64_tr_b16 v[70:71], v21 offset:57856
    ds_write_b32 v29, v34 offset:512
    v_cvt_pk_bf16_f32 v212, -v38, -v38
    v_and_b32 v212, 0xffff0000, v212
    v_sub_f32 v212, -v38, v212
    v_mfma_f32_32x32x16_bf16 v[132:147], a[156:159], v[60:63], v[132:147]
    s_add_u32 m0, s8, 155648
    s_add_u32 s88, s78, s5
    buffer_load_dwordx4 v6, s[28:31], s88 offen lds
    s_waitcnt lgkmcnt(3)
    v_cvt_pk_bf16_f32 v212, -v38, v212
    v_mfma_f32_16x16x32_bf16 v[56:59], v[40:43], v[64:67], v[56:59]
    v_mfma_f32_32x32x16_bf16 v[116:131], a[32:35], v[64:67], v[116:131]
    ds_read_b64_tr_b16 v[60:61], v20 offset:61440
    ds_read_b64_tr_b16 v[62:63], v20 offset:61952
    buffer_load_dwordx4 v7, s[28:31], s88 offen offset:1024 lds
    v_cndmask_b32 v80, v212, 0, s[18:19]
    v_mfma_f32_32x32x16_bf16 v[132:147], a[160:163], v[64:67], v[132:147]
    s_waitcnt lgkmcnt(3)
    v_mfma_f32_32x32x16_bf16 v[116:131], a[36:39], v[68:71], v[116:131]
    ds_read_b64_tr_b16 v[64:65], v21 offset:61440
    ds_read_b64_tr_b16 v[66:67], v21 offset:61952
    v_mfma_f32_32x32x16_bf16 v[132:147], a[164:167], v[68:71], v[132:147]
    s_add_u32 m0, s8, 0
    s_add_u32 s88, s79, s5
    buffer_load_dwordx4 v6, s[28:31], s88 offen lds
    s_waitcnt vmcnt(11) lgkmcnt(2)
    s_barrier
    v_mfma_f32_16x16x32_bf16 v[56:59], v[40:43], v[60:63], v[56:59]
    v_mfma_f32_32x32x16_bf16 v[116:131], a[40:43], v[60:63], v[116:131]
    ds_read_b64_tr_b16 v[68:69], v22 offset:24576
    ds_read_b64_tr_b16 v[70:71], v22 offset:25088
    buffer_load_dwordx4 v7, s[28:31], s88 offen offset:1024 lds
    ds_read_b32 v76, v30
    ds_read_b32 v35, v30 offset:512
    v_mfma_f32_32x32x16_bf16 v[132:147], a[168:171], v[60:63], v[132:147]
    s_waitcnt lgkmcnt(4)
    ds_read_b128 v[148:151], v32 offset:0
    ds_read_b128 v[152:155], v32 offset:32
    ds_read_b128 v[156:159], v32 offset:64
    ds_read_b128 v[160:163], v32 offset:96
    v_mfma_f32_32x32x16_bf16 v[116:131], a[44:47], v[64:67], v[116:131]
    ds_read_b64_tr_b16 v[60:61], v23 offset:24576
    ds_read_b64_tr_b16 v[62:63], v23 offset:25088
    ds_read_b128 v[164:167], v33 offset:0
    ds_read_b128 v[168:171], v33 offset:32
    ds_read_b128 v[172:175], v33 offset:64
    ds_read_b128 v[176:179], v33 offset:96
    v_mfma_f32_32x32x16_bf16 v[132:147], a[172:175], v[64:67], v[132:147]
    s_add_u32 m0, s8, 8192
    s_add_u32 s88, s82, s6
    buffer_load_dwordx4 v8, s[32:35], s88 offen lds
    s_waitcnt lgkmcnt(12)
    v_mfma_f32_16x16x32_bf16 v[56:59], v[40:43], v[68:71], v[56:59]
    v_mfma_f32_32x32x16_bf16 v[116:131], a[48:51], v[68:71], v[116:131]
    ds_read_b64_tr_b16 v[64:65], v22 offset:28672
    ds_read_b64_tr_b16 v[66:67], v22 offset:29184
    buffer_load_dwordx4 v9, s[32:35], s88 offen offset:1024 lds
    s_waitcnt lgkmcnt(2)
    v_mfma_f32_32x32x16_bf16 v[132:147], a[176:179], v[68:71], v[132:147]
    v_mfma_f32_32x32x16_bf16 v[84:99], v[72:75], v[80:83], v[84:99]
    v_mfma_f32_32x32x16_bf16 v[100:115], v[76:79], v[80:83], v[100:115]
    v_mfma_f32_32x32x16_bf16 v[116:131], a[52:55], v[60:63], v[116:131]
    ds_read_b64_tr_b16 v[68:69], v23 offset:28672
    ds_read_b64_tr_b16 v[70:71], v23 offset:29184
    s_add_u32 m0, s8, 106496
    s_add_u32 s88, s83, s6
    buffer_load_dwordx4 v8, s[32:35], s88 offen lds
    v_mfma_f32_32x32x16_bf16 v[132:147], a[180:183], v[60:63], v[132:147]
    buffer_load_dwordx4 v9, s[32:35], s88 offen offset:1024 lds
    s_waitcnt vmcnt(14) lgkmcnt(2)
    s_barrier
    s_nop 0
    v_pk_mul_f32 v[84:85], v[84:85], v[148:149]
    v_pk_mul_f32 v[86:87], v[86:87], v[150:151]
    v_pk_mul_f32 v[88:89], v[88:89], v[152:153]
    v_pk_mul_f32 v[90:91], v[90:91], v[154:155]
    v_pk_mul_f32 v[92:93], v[92:93], v[156:157]
    v_pk_mul_f32 v[94:95], v[94:95], v[158:159]
    v_pk_mul_f32 v[96:97], v[96:97], v[160:161]
    v_pk_mul_f32 v[98:99], v[98:99], v[162:163]
    v_pk_mul_f32 v[100:101], v[100:101], v[164:165]
    v_pk_mul_f32 v[102:103], v[102:103], v[166:167]
    v_pk_mul_f32 v[104:105], v[104:105], v[168:169]
    v_pk_mul_f32 v[106:107], v[106:107], v[170:171]
    v_pk_mul_f32 v[108:109], v[108:109], v[172:173]
    v_pk_mul_f32 v[110:111], v[110:111], v[174:175]
    v_pk_mul_f32 v[112:113], v[112:113], v[176:177]
    v_pk_mul_f32 v[114:115], v[114:115], v[178:179]
    v_pk_mul_f32 v[212:213], v[84:85], s[14:15]
    v_pk_mul_f32 v[214:215], v[86:87], s[14:15]
    v_pk_mul_f32 v[216:217], v[88:89], s[14:15]
    v_pk_mul_f32 v[218:219], v[90:91], s[14:15]
    v_pk_mul_f32 v[220:221], v[92:93], s[14:15]
    v_pk_mul_f32 v[222:223], v[94:95], s[14:15]
    v_pk_mul_f32 v[224:225], v[96:97], s[14:15]
    v_pk_mul_f32 v[226:227], v[98:99], s[14:15]
    v_pk_mul_f32 v[228:229], v[100:101], s[14:15]
    v_pk_mul_f32 v[230:231], v[102:103], s[14:15]
    v_pk_mul_f32 v[232:233], v[104:105], s[14:15]
    v_pk_mul_f32 v[234:235], v[106:107], s[14:15]
    v_pk_mul_f32 v[236:237], v[108:109], s[14:15]
    v_pk_mul_f32 v[238:239], v[110:111], s[14:15]
    v_pk_mul_f32 v[240:241], v[112:113], s[14:15]
    v_pk_mul_f32 v[242:243], v[114:115], s[14:15]
    s_add_u32 m0, s8, 16384
    s_add_u32 s88, s84, s6
    buffer_load_dwordx4 v8, s[32:35], s88 offen lds
    v_mfma_f32_16x16x32_bf16 v[56:59], v[40:43], v[64:67], v[56:59]
    v_mfma_f32_32x32x16_bf16 v[116:131], a[56:59], v[64:67], v[116:131]
    ds_read_b64_tr_b16 v[60:61], v22 offset:32768
    ds_read_b64_tr_b16 v[62:63], v22 offset:33280
    buffer_load_dwordx4 v9, s[32:35], s88 offen offset:1024 lds
    v_exp_f32_e64 v212, v212 clamp
    v_mfma_f32_32x32x16_bf16 v[132:147], a[184:187], v[64:67], v[132:147]
    s_waitcnt lgkmcnt(2)
    v_max_f32 v84, s13, v84
    v_exp_f32_e64 v213, v213 clamp
    v_max_f32 v85, s13, v85
    v_mfma_f32_32x32x16_bf16 v[116:131], a[60:63], v[68:71], v[116:131]
    ds_read_b64_tr_b16 v[64:65], v23 offset:32768
    ds_read_b64_tr_b16 v[66:67], v23 offset:33280
    v_exp_f32_e64 v214, v214 clamp
    v_max_f32 v86, s13, v86
    v_exp_f32_e64 v215, v215 clamp
    v_mfma_f32_32x32x16_bf16 v[132:147], a[188:191], v[68:71], v[132:147]
    s_waitcnt lgkmcnt(2)
    v_max_f32 v87, s13, v87
    v_exp_f32_e64 v216, v216 clamp
    v_max_f32 v88, s13, v88
    v_mfma_f32_16x16x32_bf16 v[56:59], v[40:43], v[60:63], v[56:59]
    v_mfma_f32_32x32x16_bf16 v[116:131], a[64:67], v[60:63], v[116:131]
    ds_read_b64_tr_b16 v[68:69], v22 offset:36864
    ds_read_b64_tr_b16 v[70:71], v22 offset:37376
    s_add_u32 m0, s8, 24576
    s_add_u32 s88, s85, s6
    buffer_load_dwordx4 v8, s[32:35], s88 offen lds
    v_mfma_f32_32x32x16_bf16 v[132:147], a[192:195], v[60:63], v[132:147]
    buffer_load_dwordx4 v9, s[32:35], s88 offen offset:1024 lds
    s_waitcnt lgkmcnt(2)
    v_exp_f32_e64 v217, v217 clamp
    v_max_f32 v89, s13, v89
    v_mfma_f32_32x32x16_bf16 v[116:131], a[68:71], v[64:67], v[116:131]
    ds_read_b64_tr_b16 v[60:61], v23 offset:36864
    ds_read_b64_tr_b16 v[62:63], v23 offset:37376
    v_exp_f32_e64 v218, v218 clamp
    v_max_f32 v90, s13, v90
    v_exp_f32_e64 v219, v219 clamp
    v_mfma_f32_32x32x16_bf16 v[132:147], a[196:199], v[64:67], v[132:147]
    s_waitcnt vmcnt(12) lgkmcnt(2)
    s_barrier
    v_max_f32 v91, s13, v91
    v_exp_f32_e64 v220, v220 clamp
    v_max_f32 v92, s13, v92
    v_mfma_f32_16x16x32_bf16 v[56:59], v[40:43], v[68:71], v[56:59]
    v_mfma_f32_32x32x16_bf16 v[116:131], a[72:75], v[68:71], v[116:131]
    ds_read_b64_tr_b16 v[64:65], v24 offset:16384
    ds_read_b64_tr_b16 v[66:67], v24 offset:16896
    v_exp_f32_e64 v221, v221 clamp
    v_max_f32 v93, s13, v93
    v_exp_f32_e64 v222, v222 clamp
    v_mfma_f32_32x32x16_bf16 v[132:147], a[200:203], v[68:71], v[132:147]
    s_add_u32 m0, s8, 114688
    s_add_u32 s88, s86, s6
    buffer_load_dwordx4 v8, s[32:35], s88 offen lds
    s_waitcnt lgkmcnt(2)
    v_max_f32 v94, s13, v94
    v_mfma_f32_32x32x16_bf16 v[116:131], a[76:79], v[60:63], v[116:131]
    ds_read_b64_tr_b16 v[68:69], v25 offset:16384
    ds_read_b64_tr_b16 v[70:71], v25 offset:16896
    buffer_load_dwordx4 v9, s[32:35], s88 offen offset:1024 lds
    v_exp_f32_e64 v223, v223 clamp
    v_max_f32 v95, s13, v95
    v_mfma_f32_32x32x16_bf16 v[132:147], a[204:207], v[60:63], v[132:147]
    s_waitcnt lgkmcnt(2)
    v_exp_f32_e64 v224, v224 clamp
    v_max_f32 v96, s13, v96
    v_exp_f32_e64 v225, v225 clamp
    v_mfma_f32_16x16x32_bf16 v[56:59], v[40:43], v[64:67], v[56:59]
    v_mfma_f32_32x32x16_bf16 v[116:131], a[80:83], v[64:67], v[116:131]
    ds_read_b64_tr_b16 v[60:61], v24 offset:20480
    ds_read_b64_tr_b16 v[62:63], v24 offset:20992
    v_max_f32 v97, s13, v97
    v_exp_f32_e64 v226, v226 clamp
    v_max_f32 v98, s13, v98
    v_mfma_f32_32x32x16_bf16 v[132:147], a[208:211], v[64:67], v[132:147]
    s_waitcnt lgkmcnt(2)
    v_exp_f32_e64 v227, v227 clamp
    v_max_f32 v99, s13, v99
    v_exp_f32_e64 v228, v228 clamp
    v_mfma_f32_32x32x16_bf16 v[116:131], a[84:87], v[68:71], v[116:131]
    ds_read_b64_tr_b16 v[64:65], v25 offset:20480
    ds_read_b64_tr_b16 v[66:67], v25 offset:20992
    s_add_u32 m0, s8, 32768
    s_add_u32 s88, s87, s6
    buffer_load_dwordx4 v8, s[32:35], s88 offen lds
    v_max_f32 v100, s13, v100
    v_mfma_f32_32x32x16_bf16 v[132:147], a[212:215], v[68:71], v[132:147]
    buffer_load_dwordx4 v9, s[32:35], s88 offen offset:1024 lds
    s_waitcnt vmcnt(14) lgkmcnt(2)
    s_barrier
    v_exp_f32_e64 v229, v229 clamp
    v_max_f32 v101, s13, v101
    v_mfma_f32_16x16x32_bf16 v[56:59], v[40:43], v[60:63], v[56:59]
    v_mfma_f32_32x32x16_bf16 v[116:131], a[88:91], v[60:63], v[116:131]
    ds_read_b64_tr_b16 v[68:69], v24 offset:24576
    ds_read_b64_tr_b16 v[70:71], v24 offset:25088
    v_exp_f32_e64 v230, v230 clamp
    v_max_f32 v102, s13, v102
    v_exp_f32_e64 v231, v231 clamp
    v_mfma_f32_32x32x16_bf16 v[132:147], a[216:219], v[60:63], v[132:147]
    s_waitcnt lgkmcnt(2)
    v_max_f32 v103, s13, v103
    v_exp_f32_e64 v232, v232 clamp
    v_max_f32 v104, s13, v104
    v_mfma_f32_32x32x16_bf16 v[116:131], a[92:95], v[64:67], v[116:131]
    ds_read_b64_tr_b16 v[60:61], v25 offset:24576
    ds_read_b64_tr_b16 v[62:63], v25 offset:25088
    v_exp_f32_e64 v233, v233 clamp
    v_max_f32 v105, s13, v105
    v_exp_f32_e64 v234, v234 clamp
    v_mfma_f32_32x32x16_bf16 v[132:147], a[220:223], v[64:67], v[132:147]
    s_add_u32 m0, s8, 40960
    s_xor_b32 s88, s12, 0
    s_add_u32 s88, s88, s97
    buffer_load_dwordx4 v10, s[44:47], s88 offen lds
    s_waitcnt lgkmcnt(2)
    v_max_f32 v106, s13, v106
    v_mfma_f32_16x16x32_bf16 v[56:59], v[40:43], v[68:71], v[56:59]
    v_mfma_f32_32x32x16_bf16 v[116:131], a[96:99], v[68:71], v[116:131]
    ds_read_b64_tr_b16 v[64:65], v24 offset:28672
    ds_read_b64_tr_b16 v[66:67], v24 offset:29184
    buffer_load_dwordx4 v11, s[44:47], s88 offen offset:1024 lds
    v_exp_f32_e64 v235, v235 clamp
    v_max_f32 v107, s13, v107
    v_mfma_f32_32x32x16_bf16 v[132:147], a[224:227], v[68:71], v[132:147]
    s_waitcnt lgkmcnt(2)
    v_exp_f32_e64 v236, v236 clamp
    v_max_f32 v108, s13, v108
    v_exp_f32_e64 v237, v237 clamp
    v_mfma_f32_32x32x16_bf16 v[116:131], a[100:103], v[60:63], v[116:131]
    ds_read_b64_tr_b16 v[68:69], v25 offset:28672
    ds_read_b64_tr_b16 v[70:71], v25 offset:29184
    v_max_f32 v109, s13, v109
    v_exp_f32_e64 v238, v238 clamp
    v_max_f32 v110, s13, v110
    v_mfma_f32_32x32x16_bf16 v[132:147], a[228:231], v[60:63], v[132:147]
    s_add_u32 m0, s8, 122880
    s_xor_b32 s88, s12, 16384
    s_add_u32 s88, s88, s97
    buffer_load_dwordx4 v10, s[44:47], s88 offen lds
    s_waitcnt vmcnt(15) lgkmcnt(2)
    s_barrier
    v_mfma_f32_16x16x32_bf16 v[56:59], v[40:43], v[64:67], v[56:59]
    v_mfma_f32_32x32x16_bf16 v[116:131], a[104:107], v[64:67], v[116:131]
    ds_read_b64_tr_b16 v[60:61], v20 offset:0
    ds_read_b64_tr_b16 v[62:63], v20 offset:512
    buffer_load_dwordx4 v11, s[44:47], s88 offen offset:1024 lds
    v_exp_f32_e64 v239, v239 clamp
    v_max_f32 v111, s13, v111
    v_mfma_f32_32x32x16_bf16 v[132:147], a[232:235], v[64:67], v[132:147]
    s_waitcnt lgkmcnt(2)
    v_exp_f32_e64 v240, v240 clamp
    v_max_f32 v112, s13, v112
    v_exp_f32_e64 v241, v241 clamp
    v_mfma_f32_32x32x16_bf16 v[116:131], a[108:111], v[68:71], v[116:131]
    ds_read_b64_tr_b16 v[64:65], v21 offset:0
    ds_read_b64_tr_b16 v[66:67], v21 offset:512
    s_add_u32 m0, s8, 65536
    s_xor_b32 s88, s12, 32768
    s_add_u32 s88, s88, s97
    buffer_load_dwordx4 v10, s[44:47], s88 offen lds
    v_mfma_f32_32x32x16_bf16 v[132:147], a[236:239], v[68:71], v[132:147]
    buffer_load_dwordx4 v11, s[44:47], s88 offen offset:1024 lds
    v_cndmask_b32 v37, v56, v57, s[16:17]
    ds_write_b32 v26, v37
    s_waitcnt lgkmcnt(3)
    v_max_f32 v113, s13, v113
    v_mfma_f32_16x16x32_bf16 v[56:59], v[40:43], v[60:63], v[56:59]
    v_mfma_f32_32x32x16_bf16 v[116:131], a[112:115], v[60:63], v[116:131]
    ds_read_b64_tr_b16 v[68:69], v20 offset:4096
    ds_read_b64_tr_b16 v[70:71], v20 offset:4608
    v_exp_f32_e64 v242, v242 clamp
    v_max_f32 v114, s13, v114
    v_exp_f32_e64 v243, v243 clamp
    v_mfma_f32_32x32x16_bf16 v[132:147], a[240:243], v[60:63], v[132:147]
    s_waitcnt lgkmcnt(3)
    v_max_f32 v115, s13, v115
    v_pk_add_f32 v[84:85], v[84:85], v[212:213]
    v_pk_add_f32 v[86:87], v[86:87], v[214:215]
    v_pk_add_f32 v[88:89], v[88:89], v[216:217]
    v_pk_add_f32 v[90:91], v[90:91], v[218:219]
    v_pk_add_f32 v[92:93], v[92:93], v[220:221]
    v_pk_add_f32 v[94:95], v[94:95], v[222:223]
    v_pk_add_f32 v[96:97], v[96:97], v[224:225]
    v_pk_add_f32 v[98:99], v[98:99], v[226:227]
    v_pk_add_f32 v[100:101], v[100:101], v[228:229]
    v_pk_add_f32 v[102:103], v[102:103], v[230:231]
    v_pk_add_f32 v[104:105], v[104:105], v[232:233]
    v_pk_add_f32 v[106:107], v[106:107], v[234:235]
    v_pk_add_f32 v[108:109], v[108:109], v[236:237]
    v_pk_add_f32 v[110:111], v[110:111], v[238:239]
    v_pk_add_f32 v[112:113], v[112:113], v[240:241]
    v_pk_add_f32 v[114:115], v[114:115], v[242:243]
    s_add_u32 m0, s8, 73728
    s_xor_b32 s88, s12, 49152
    s_add_u32 s88, s88, s97
    buffer_load_dwordx4 v10, s[44:47], s88 offen lds
    v_mfma_f32_16x16x32_bf16 v[56:59], v[40:43], v[64:67], v[56:59]
    v_mfma_f32_32x32x16_bf16 v[116:131], a[116:119], v[64:67], v[116:131]
    ds_read_b64_tr_b16 v[60:61], v21 offset:4096
    ds_read_b64_tr_b16 v[62:63], v21 offset:4608
    buffer_load_dwordx4 v11, s[44:47], s88 offen offset:1024 lds
    v_cvt_pk_bf16_f32 v180, v84, v85
    v_cvt_pk_bf16_f32 v181, v86, v87
    v_cvt_pk_bf16_f32 v182, v88, v89
    v_mfma_f32_32x32x16_bf16 v[132:147], a[244:247], v[64:67], v[132:147]
    s_add_u32 m0, s8, 57344
    s_xor_b32 s88, s12, 65536
    s_add_u32 s88, s88, s97
    buffer_load_dwordx4 v10, s[44:47], s88 offen lds
    s_waitcnt lgkmcnt(2)
    s_barrier
    v_mfma_f32_16x16x32_bf16 v[56:59], v[40:43], v[68:71], v[56:59]
    v_mfma_f32_32x32x16_bf16 v[116:131], a[120:123], v[68:71], v[116:131]
    ds_read_b64_tr_b16 v[64:65], v22 offset:16384
    ds_read_b64_tr_b16 v[66:67], v22 offset:16896
    buffer_load_dwordx4 v11, s[44:47], s88 offen offset:1024 lds
    v_cvt_pk_bf16_f32 v183, v90, v91
    v_cvt_pk_bf16_f32 v184, v92, v93
    v_cvt_pk_bf16_f32 v185, v94, v95
    v_mfma_f32_32x32x16_bf16 v[132:147], a[248:251], v[68:71], v[132:147]
    ds_read_b32 v36, v27
    s_waitcnt lgkmcnt(3)
    v_cvt_pk_bf16_f32 v186, v96, v97
    v_cvt_pk_bf16_f32 v187, v98, v99
    v_cvt_pk_bf16_f32 v188, v100, v101
    v_cvt_pk_bf16_f32 v189, v102, v103
    v_cvt_pk_bf16_f32 v190, v104, v105
    v_mfma_f32_16x16x32_bf16 v[56:59], v[40:43], v[60:63], v[56:59]
    v_mfma_f32_32x32x16_bf16 v[116:131], a[124:127], v[60:63], v[116:131]
    ds_read_b64_tr_b16 v[68:69], v23 offset:16384
    ds_read_b64_tr_b16 v[70:71], v23 offset:16896
    s_add_u32 m0, s8, 90112
    s_xor_b32 s88, s12, 81920
    s_add_u32 s88, s88, s97
    buffer_load_dwordx4 v10, s[44:47], s88 offen lds
    v_mfma_f32_32x32x16_bf16 v[132:147], a[252:255], v[60:63], v[132:147]
    buffer_load_dwordx4 v11, s[44:47], s88 offen offset:1024 lds
    s_waitcnt lgkmcnt(3)
    v_cvt_pk_bf16_f32 v191, v106, v107
    v_cvt_pk_bf16_f32 v192, v108, v109
    v_cvt_pk_bf16_f32 v193, v110, v111
    v_cvt_pk_bf16_f32 v194, v112, v113
    v_cvt_pk_bf16_f32 v195, v114, v115
    s_waitcnt lgkmcnt(2)
    v_cndmask_b32 v38, v56, v57, s[16:17]
    v_mfma_f32_16x16x32_bf16 v[56:59], v[40:43], v[64:67], 0
    v_mfma_f32_32x32x16_bf16 v[84:99], v[64:67], a[0:3], 0
    ds_read_b64_tr_b16 v[60:61], v22 offset:20480
    ds_read_b64_tr_b16 v[62:63], v22 offset:20992
    v_add_f32 v38, v38, v36
    v_cvt_pk_bf16_f32 v212, -v38, -v38
    v_and_b32 v212, 0xffff0000, v212
    v_sub_f32 v212, -v38, v212
    v_mfma_f32_32x32x16_bf16 v[100:115], v[64:67], a[128:131], 0
    s_waitcnt lgkmcnt(2)
    v_cvt_pk_bf16_f32 v212, -v38, v212
    v_cndmask_b32 v80, v212, 0, s[18:19]
    s_nop 1
    v_mfma_f32_32x32x16_bf16 v[116:131], v[72:75], v[80:83], v[116:131]
    s_add_u32 m0, s8, 98304
    s_xor_b32 s88, s12, 98304
    s_add_u32 s88, s88, s97
    buffer_load_dwordx4 v10, s[44:47], s88 offen lds
    v_mfma_f32_32x32x16_bf16 v[132:147], v[76:79], v[80:83], v[132:147]
    buffer_load_dwordx4 v11, s[44:47], s88 offen offset:1024 lds
    v_mfma_f32_32x32x16_bf16 v[84:99], v[68:71], a[4:7], v[84:99]
    ds_read_b64_tr_b16 v[64:65], v23 offset:20480
    ds_read_b64_tr_b16 v[66:67], v23 offset:20992
    v_mfma_f32_32x32x16_bf16 v[100:115], v[68:71], a[132:135], v[100:115]
    s_waitcnt lgkmcnt(2)
    s_barrier
    v_mfma_f32_16x16x32_bf16 v[44:47], v[40:43], v[180:183], 0
    v_mfma_f32_16x16x32_bf16 v[44:47], v[40:43], v[184:187], v[44:47]
    v_mfma_f32_16x16x32_bf16 v[44:47], v[40:43], v[188:191], v[44:47]
    v_mfma_f32_16x16x32_bf16 v[44:47], v[40:43], v[192:195], v[44:47]
    v_pk_mul_f32 v[116:117], v[116:117], v[148:149]
    v_pk_mul_f32 v[118:119], v[118:119], v[150:151]
    v_pk_mul_f32 v[120:121], v[120:121], v[152:153]
    v_pk_mul_f32 v[122:123], v[122:123], v[154:155]
    v_pk_mul_f32 v[124:125], v[124:125], v[156:157]
    v_pk_mul_f32 v[126:127], v[126:127], v[158:159]
    v_pk_mul_f32 v[128:129], v[128:129], v[160:161]
    v_pk_mul_f32 v[130:131], v[130:131], v[162:163]
    v_pk_mul_f32 v[132:133], v[132:133], v[164:165]
    v_pk_mul_f32 v[134:135], v[134:135], v[166:167]
    v_pk_mul_f32 v[136:137], v[136:137], v[168:169]
    v_pk_mul_f32 v[138:139], v[138:139], v[170:171]
    v_pk_mul_f32 v[140:141], v[140:141], v[172:173]
    v_pk_mul_f32 v[142:143], v[142:143], v[174:175]
    v_pk_mul_f32 v[144:145], v[144:145], v[176:177]
    v_pk_mul_f32 v[146:147], v[146:147], v[178:179]
    s_add_u32 m0, s8, 147456
    s_xor_b32 s88, s12, 114688
    s_add_u32 s88, s88, s97
    buffer_load_dwordx4 v10, s[44:47], s88 offen lds
    v_cvt_pk_bf16_f32 v196, v116, v117
    v_cvt_pk_bf16_f32 v197, v118, v119
    v_cvt_pk_bf16_f32 v198, v120, v121
    v_cvt_pk_bf16_f32 v199, v122, v123
    v_cvt_pk_bf16_f32 v200, v124, v125
    v_cvt_pk_bf16_f32 v201, v126, v127
    v_cvt_pk_bf16_f32 v202, v128, v129
    v_cvt_pk_bf16_f32 v203, v130, v131
    v_cvt_pk_bf16_f32 v204, v132, v133
    v_cvt_pk_bf16_f32 v205, v134, v135
    v_cvt_pk_bf16_f32 v206, v136, v137
    v_cvt_pk_bf16_f32 v207, v138, v139
    v_cvt_pk_bf16_f32 v208, v140, v141
    v_cvt_pk_bf16_f32 v209, v142, v143
    v_cvt_pk_bf16_f32 v210, v144, v145
    v_cvt_pk_bf16_f32 v211, v146, v147
    buffer_load_dwordx4 v11, s[44:47], s88 offen offset:1024 lds
    v_mfma_f32_32x32x16_bf16 v[116:131], v[180:183], v[196:199], 0
    s_add_u32 m0, s8, 155648
    s_xor_b32 s88, s12, 0
    s_add_u32 s88, s88, s98
    buffer_load_dwordx4 v10, s[48:51], s88 offen lds
    v_bfe_u32 v228, v1, 4, 1
    v_mfma_f32_32x32x16_bf16 v[116:131], v[184:187], v[200:203], v[116:131]
    buffer_load_dwordx4 v11, s[48:51], s88 offen offset:1024 lds
    v_mul_u32_u24 v228, 1088, v228
    s_mul_i32 s89, s60, 4352
    s_mul_i32 s90, s61, 2176
    s_add_u32 s89, s89, s90
    s_add_u32 s89, s89, 133120
    v_add_u32 v228, s89, v228
    v_mfma_f32_32x32x16_bf16 v[116:131], v[188:191], v[204:207], v[116:131]
    v_lshrrev_b32 v229, 5, v1
    v_lshrrev_b32 v230, 1, v244
    v_add_u32 v230, v230, v228
    v_lshl_add_u32 v228, v229, 8, v228
    v_mfma_f32_32x32x16_bf16 v[116:131], v[192:195], v[208:211], v[116:131]
    s_add_u32 m0, s8, 0
    s_xor_b32 s88, s12, 16384
    s_add_u32 s88, s88, s98
    buffer_load_dwordx4 v10, s[48:51], s88 offen lds
    v_lshl_add_u32 v228, v244, 1, v228
    v_lshlrev_b32 v231, 2, v0
    v_add_u32 v232, 133120, v231
    v_cndmask_b32 v220, v44, v45, s[16:17]
    ds_write_b32 v230, v220 offset:1024
    v_mfma_f32_16x16x32_bf16 v[56:59], v[40:43], v[60:63], v[56:59]
    v_mfma_f32_32x32x16_bf16 v[84:99], v[60:63], a[8:11], v[84:99]
    ds_read_b64_tr_b16 v[68:69], v20 offset:49152
    ds_read_b64_tr_b16 v[70:71], v20 offset:49664
    buffer_load_dwordx4 v11, s[48:51], s88 offen offset:1024 lds
    v_mfma_f32_32x32x16_bf16 v[100:115], v[60:63], a[136:139], v[100:115]
    s_waitcnt lgkmcnt(3)
    v_mfma_f32_32x32x16_bf16 v[84:99], v[64:67], a[12:15], v[84:99]
    ds_read_b64_tr_b16 v[60:61], v21 offset:49152
    ds_read_b64_tr_b16 v[62:63], v21 offset:49664
    v_cndmask_b32 v212, v116, v124, s[16:17]
    v_cndmask_b32 v213, v117, v125, s[16:17]
    v_cndmask_b32 v214, v118, v126, s[16:17]
    v_cndmask_b32 v215, v119, v127, s[16:17]
    v_mfma_f32_32x32x16_bf16 v[100:115], v[64:67], a[140:143], v[100:115]
    s_waitcnt lgkmcnt(2)
    v_cndmask_b32 v216, v120, v128, s[16:17]
    v_cndmask_b32 v217, v121, v129, s[16:17]
    v_cndmask_b32 v218, v122, v130, s[16:17]
    v_cndmask_b32 v219, v123, v131, s[16:17]
    v_mfma_f32_16x16x32_bf16 v[56:59], v[40:43], v[68:71], v[56:59]
    v_mfma_f32_32x32x16_bf16 v[84:99], v[68:71], a[16:19], v[84:99]
    ds_read_b64_tr_b16 v[64:65], v20 offset:53248
    ds_read_b64_tr_b16 v[66:67], v20 offset:53760
    ds_write_b128 v228, v[212:215]
    ds_write_b128 v228, v[216:219] offset:512
    v_add_u32 v12, s8, v247
    v_xor_b32 v13, 64, v12
    v_mfma_f32_32x32x16_bf16 v[100:115], v[68:71], a[144:147], v[100:115]
    s_waitcnt lgkmcnt(4)
    v_add_u32 v14, 65536, v12
    v_add_u32 v15, 65536, v13
    v_add_u32 v16, 131072, v12
    v_add_u32 v17, 131072, v13
    v_mfma_f32_32x32x16_bf16 v[84:99], v[60:63], a[20:23], v[84:99]
    ds_read_b64_tr_b16 v[68:69], v21 offset:53248
    ds_read_b64_tr_b16 v[70:71], v21 offset:53760
    v_lshrrev_b32 v2, 5, v1
    v_lshlrev_b32 v3, 8, v2
    v_lshl_add_u32 v3, v244, 1, v3
    v_lshlrev_b32 v2, 4, v2
    v_mfma_f32_32x32x16_bf16 v[100:115], v[60:63], a[148:151], v[100:115]
    s_waitcnt vmcnt(30) lgkmcnt(2)
    s_barrier
    v_add_u32 v2, 1024, v2
    v_cndmask_b32 v18, v3, v2, s[16:17]
    v_add_u32 v3, 480, v3
    v_cndmask_b32 v4, v3, v2, s[16:17]
    v_mfma_f32_16x16x32_bf16 v[56:59], v[40:43], v[64:67], v[56:59]
    v_mfma_f32_32x32x16_bf16 v[84:99], v[64:67], a[24:27], v[84:99]
    ds_read_b64_tr_b16 v[60:61], v20 offset:8192
    ds_read_b64_tr_b16 v[62:63], v20 offset:8704
    s_add_u32 m0, s8, 81920
    s_xor_b32 s88, s12, 32768
    s_add_u32 s88, s88, s98
    buffer_load_dwordx4 v10, s[48:51], s88 offen lds
    v_mfma_f32_32x32x16_bf16 v[100:115], v[64:67], a[152:155], v[100:115]
    buffer_load_dwordx4 v11, s[48:51], s88 offen offset:1024 lds
    s_waitcnt lgkmcnt(2)
    v_lshrrev_b32 v2, 3, v0
    v_and_b32 v3, 7, v0
    v_lshlrev_b32 v3, 4, v3
    v_mfma_f32_32x32x16_bf16 v[84:99], v[68:71], a[28:31], v[84:99]
    ds_read_b64_tr_b16 v[64:65], v21 offset:8192
    ds_read_b64_tr_b16 v[66:67], v21 offset:8704
    v_lshl_add_u32 v19, v2, 10, v3
    ds_read2st64_b32 v[212:213], v232 offset0:0 offset1:17
    ds_read2st64_b32 v[214:215], v232 offset0:4 offset1:21
    ds_read2st64_b32 v[216:217], v232 offset0:8 offset1:25
    v_mfma_f32_32x32x16_bf16 v[100:115], v[68:71], a[156:159], v[100:115]
    s_waitcnt lgkmcnt(5)
    ds_read2st64_b32 v[218:219], v232 offset0:12 offset1:29
    ds_read2st64_b32 v[220:221], v232 offset0:16 offset1:33
    v_mfma_f32_16x16x32_bf16 v[56:59], v[40:43], v[60:63], v[56:59]
    v_mfma_f32_32x32x16_bf16 v[84:99], v[60:63], a[32:35], v[84:99]
    ds_read_b64_tr_b16 v[68:69], v20 offset:12288
    ds_read_b64_tr_b16 v[70:71], v20 offset:12800
    s_waitcnt lgkmcnt(2)
    v_add_f32 v212, v212, v213
    v_add_f32 v214, v214, v215
    v_add_f32 v216, v216, v217
    v_mfma_f32_32x32x16_bf16 v[100:115], v[60:63], a[160:163], v[100:115]
    v_add_f32 v218, v218, v219
    v_add_f32 v220, v220, v221
    v_mfma_f32_32x32x16_bf16 v[84:99], v[64:67], a[36:39], v[84:99]
    ds_read_b64_tr_b16 v[60:61], v21 offset:12288
    ds_read_b64_tr_b16 v[62:63], v21 offset:12800
    s_mul_i32 s9, s58, 4352
    s_add_u32 s9, s9, 10485760
    buffer_atomic_add_f32 v212, v231, s[36:39], s9 offen offset:0
    v_mfma_f32_32x32x16_bf16 v[100:115], v[64:67], a[164:167], v[100:115]
    buffer_atomic_add_f32 v214, v231, s[36:39], s9 offen offset:1024
    s_waitcnt vmcnt(32) lgkmcnt(2)
    s_barrier
    buffer_load_dwordx2 v[248:249], v244, s[36:39], s2 offen sc1
    v_mfma_f32_16x16x32_bf16 v[56:59], v[40:43], v[68:71], v[56:59]
    v_mfma_f32_32x32x16_bf16 v[84:99], v[68:71], a[40:43], v[84:99]
    ds_read_b64_tr_b16 v[64:65], v22 offset:40960
    ds_read_b64_tr_b16 v[66:67], v22 offset:41472
    buffer_atomic_add_f32 v216, v231, s[36:39], s9 offen offset:2048
    v_mfma_f32_32x32x16_bf16 v[100:115], v[68:71], a[168:171], v[100:115]
    buffer_atomic_add_f32 v218, v231, s[36:39], s9 offen offset:3072
    s_waitcnt lgkmcnt(2)
    v_mfma_f32_32x32x16_bf16 v[84:99], v[60:63], a[44:47], v[84:99]
    ds_read_b64_tr_b16 v[68:69], v23 offset:40960
    ds_read_b64_tr_b16 v[70:71], v23 offset:41472
    s_add_u32 s9, s9, 4096
    s_cmp_eq_u32 s59, 0
    s_cselect_b32 s9, s9, 1073741824
    buffer_atomic_add_f32 v220, v231, s[36:39], s9 offen
    v_mfma_f32_32x32x16_bf16 v[100:115], v[60:63], a[172:175], v[100:115]
    s_add_u32 m0, s8, 49152
    s_xor_b32 s88, s12, 49152
    s_add_u32 s88, s88, s98
    buffer_load_dwordx4 v10, s[48:51], s88 offen lds
    s_waitcnt lgkmcnt(2)
    v_mfma_f32_16x16x32_bf16 v[56:59], v[40:43], v[64:67], v[56:59]
    v_mfma_f32_32x32x16_bf16 v[84:99], v[64:67], a[48:51], v[84:99]
    ds_read_b64_tr_b16 v[60:61], v22 offset:45056
    ds_read_b64_tr_b16 v[62:63], v22 offset:45568
    buffer_load_dwordx4 v11, s[48:51], s88 offen offset:1024 lds
    s_waitcnt vmcnt(28)
    ds_read_b64_tr_b16 a[32:33], v12 offset:40960
    ds_read_b64_tr_b16 a[34:35], v12 offset:41984
    v_mfma_f32_32x32x16_bf16 v[100:115], v[64:67], a[176:179], v[100:115]
    s_waitcnt lgkmcnt(4)
    v_mfma_f32_32x32x16_bf16 v[84:99], v[68:71], a[52:55], v[84:99]
    ds_read_b64_tr_b16 v[64:65], v23 offset:45056
    ds_read_b64_tr_b16 v[66:67], v23 offset:45568
    ds_read_b64_tr_b16 a[36:37], v13 offset:40960
    ds_read_b64_tr_b16 a[38:39], v13 offset:41984
    v_mfma_f32_32x32x16_bf16 v[100:115], v[68:71], a[180:183], v[100:115]
    s_waitcnt lgkmcnt(6)
    s_barrier
    v_mfma_f32_16x16x32_bf16 v[56:59], v[40:43], v[60:63], v[56:59]
    v_mfma_f32_32x32x16_bf16 v[84:99], v[60:63], a[56:59], v[84:99]
    ds_read_b64_tr_b16 v[68:69], v20 offset:16384
    ds_read_b64_tr_b16 v[70:71], v20 offset:16896
    s_add_u32 m0, s8, 8192
    s_xor_b32 s88, s12, 65536
    s_add_u32 s88, s88, s98
    buffer_load_dwordx4 v10, s[48:51], s88 offen lds
    s_waitcnt vmcnt(27)
    ds_read_b64_tr_b16 a[40:41], v14 offset:57344
    ds_read_b64_tr_b16 a[42:43], v14 offset:58368
    v_mfma_f32_32x32x16_bf16 v[100:115], v[60:63], a[184:187], v[100:115]
    buffer_load_dwordx4 v11, s[48:51], s88 offen offset:1024 lds
    s_waitcnt lgkmcnt(6)
    v_mfma_f32_32x32x16_bf16 v[84:99], v[64:67], a[60:63], v[84:99]
    ds_read_b64_tr_b16 v[60:61], v21 offset:16384
    ds_read_b64_tr_b16 v[62:63], v21 offset:16896
    ds_read_b64_tr_b16 a[44:45], v15 offset:57344
    ds_read_b64_tr_b16 a[46:47], v15 offset:58368
    v_mfma_f32_32x32x16_bf16 v[100:115], v[64:67], a[188:191], v[100:115]
    s_waitcnt lgkmcnt(6)
    v_mfma_f32_16x16x32_bf16 v[56:59], v[40:43], v[68:71], v[56:59]
    v_mfma_f32_32x32x16_bf16 v[84:99], v[68:71], a[64:67], v[84:99]
    ds_read_b64_tr_b16 v[64:65], v20 offset:20480
    ds_read_b64_tr_b16 v[66:67], v20 offset:20992
    s_waitcnt vmcnt(26)
    ds_read_b64_tr_b16 a[160:161], v14 offset:0
    ds_read_b64_tr_b16 a[162:163], v14 offset:1024
    v_mfma_f32_32x32x16_bf16 v[100:115], v[68:71], a[192:195], v[100:115]
    s_add_u32 m0, s8, 40960
    s_xor_b32 s88, s12, 81920
    s_add_u32 s88, s88, s98
    buffer_load_dwordx4 v10, s[48:51], s88 offen lds
    s_waitcnt lgkmcnt(6)
    v_mfma_f32_32x32x16_bf16 v[84:99], v[60:63], a[68:71], v[84:99]
    ds_read_b64_tr_b16 v[68:69], v21 offset:20480
    ds_read_b64_tr_b16 v[70:71], v21 offset:20992
    buffer_load_dwordx4 v11, s[48:51], s88 offen offset:1024 lds
    ds_read_b64_tr_b16 a[164:165], v15 offset:0
    ds_read_b64_tr_b16 a[166:167], v15 offset:1024
    v_mfma_f32_32x32x16_bf16 v[100:115], v[60:63], a[196:199], v[100:115]
    s_waitcnt lgkmcnt(6)
    s_barrier
    s_waitcnt vmcnt(9)
    s_mov_b32 s90, 0
    v_cmp_eq_u64 vcc, v[248:249], s[92:93]
    s_nop 1
    s_and_b32 vcc_lo, vcc_lo, 15
    s_cmp_eq_u32 vcc_lo, 15
    s_cbranch_scc1 L_POK1
L_PL1:
    s_sleep 2
    buffer_load_dwordx2 v[248:249], v244, s[36:39], s2 offen sc1
    s_waitcnt vmcnt(0)
    s_add_u32 s90, s90, 1
    s_cmp_gt_u32 s90, 200000
    s_cbranch_scc1 L_POK1
    v_cmp_eq_u64 vcc, v[248:249], s[92:93]
    s_nop 1
    s_and_b32 vcc_lo, vcc_lo, 15
    s_cmp_eq_u32 vcc_lo, 15
    s_cbranch_scc0 L_PL1
L_POK1:
    s_nop 4
    v_mfma_f32_16x16x32_bf16 v[56:59], v[40:43], v[64:67], v[56:59]
    v_mfma_f32_32x32x16_bf16 v[84:99], v[64:67], a[72:75], v[84:99]
    ds_read_b64_tr_b16 v[60:61], v20 offset:24576
    ds_read_b64_tr_b16 v[62:63], v20 offset:25088
    s_xor_b32 s9, s64, 0
    buffer_load_dwordx4 a[0:3], v28, s[36:39], s9 offen sc1
    ds_read_b64_tr_b16 a[168:169], v14 offset:8192
    ds_read_b64_tr_b16 a[170:171], v14 offset:9216
    v_mfma_f32_32x32x16_bf16 v[100:115], v[64:67], a[200:203], v[100:115]
    s_xor_b32 s9, s64, 131072
    buffer_load_dwordx4 a[4:7], v28, s[36:39], s9 offen sc1
    s_waitcnt lgkmcnt(6)
    v_mfma_f32_32x32x16_bf16 v[84:99], v[68:71], a[76:79], v[84:99]
    ds_read_b64_tr_b16 v[64:65], v21 offset:24576
    ds_read_b64_tr_b16 v[66:67], v21 offset:25088
    s_xor_b32 s9, s64, 1024
    buffer_load_dwordx4 a[8:11], v28, s[36:39], s9 offen sc1
    ds_read_b64_tr_b16 a[172:173], v15 offset:8192
    ds_read_b64_tr_b16 a[174:175], v15 offset:9216
    v_mfma_f32_32x32x16_bf16 v[100:115], v[68:71], a[204:207], v[100:115]
    s_waitcnt lgkmcnt(6)
    v_mfma_f32_16x16x32_bf16 v[56:59], v[40:43], v[60:63], v[56:59]
    v_mfma_f32_32x32x16_bf16 v[84:99], v[60:63], a[80:83], v[84:99]
    ds_read_b64_tr_b16 v[68:69], v20 offset:28672
    ds_read_b64_tr_b16 v[70:71], v20 offset:29184
    s_xor_b32 s9, s64, 132096
    buffer_load_dwordx4 a[12:15], v28, s[36:39], s9 offen sc1
    ds_read_b64_tr_b16 a[48:49], v12 offset:57344
    ds_read_b64_tr_b16 a[50:51], v12 offset:58368
    v_mfma_f32_32x32x16_bf16 v[100:115], v[60:63], a[208:211], v[100:115]
    s_xor_b32 s9, s64, 2048
    buffer_load_dwordx4 a[128:131], v28, s[36:39], s9 offen sc1
    s_waitcnt lgkmcnt(6)
    v_mfma_f32_32x32x16_bf16 v[84:99], v[64:67], a[84:87], v[84:99]
    ds_read_b64_tr_b16 v[60:61], v21 offset:28672
    ds_read_b64_tr_b16 v[62:63], v21 offset:29184
    s_xor_b32 s9, s64, 133120
    buffer_load_dwordx4 a[132:135], v28, s[36:39], s9 offen sc1
    ds_read_b64_tr_b16 a[52:53], v13 offset:57344
    ds_read_b64_tr_b16 a[54:55], v13 offset:58368
    v_mfma_f32_32x32x16_bf16 v[100:115], v[64:67], a[212:215], v[100:115]
    s_waitcnt lgkmcnt(6)
    s_barrier
    v_mfma_f32_16x16x32_bf16 v[56:59], v[40:43], v[68:71], v[56:59]
    v_mfma_f32_32x32x16_bf16 v[84:99], v[68:71], a[88:91], v[84:99]
    ds_read_b64_tr_b16 v[64:65], v22 offset:49152
    ds_read_b64_tr_b16 v[66:67], v22 offset:49664
    s_xor_b32 s9, s64, 3072
    buffer_load_dwordx4 a[136:139], v28, s[36:39], s9 offen sc1
    ds_read_b64_tr_b16 a[56:57], v14 offset:24576
    ds_read_b64_tr_b16 a[58:59], v14 offset:25600
    v_mfma_f32_32x32x16_bf16 v[100:115], v[68:71], a[216:219], v[100:115]
    s_xor_b32 s9, s64, 134144
    buffer_load_dwordx4 a[140:143], v28, s[36:39], s9 offen sc1
    s_waitcnt lgkmcnt(6)
    v_mfma_f32_32x32x16_bf16 v[84:99], v[60:63], a[92:95], v[84:99]
    ds_read_b64_tr_b16 v[68:69], v23 offset:49152
    ds_read_b64_tr_b16 v[70:71], v23 offset:49664
    s_xor_b32 s9, s64, 4096
    buffer_load_dwordx4 a[16:19], v28, s[36:39], s9 offen sc1
    ds_read_b64_tr_b16 a[60:61], v15 offset:24576
    ds_read_b64_tr_b16 a[62:63], v15 offset:25600
    v_mfma_f32_32x32x16_bf16 v[100:115], v[60:63], a[220:223], v[100:115]
    s_waitcnt lgkmcnt(6)
    v_mfma_f32_16x16x32_bf16 v[56:59], v[40:43], v[64:67], v[56:59]
    v_mfma_f32_32x32x16_bf16 v[84:99], v[64:67], a[96:99], v[84:99]
    ds_read_b64_tr_b16 v[60:61], v22 offset:53248
    ds_read_b64_tr_b16 v[62:63], v22 offset:53760
    s_xor_b32 s9, s64, 135168
    buffer_load_dwordx4 a[20:23], v28, s[36:39], s9 offen sc1
    ds_read_b64_tr_b16 a[176:177], v14 offset:32768
    ds_read_b64_tr_b16 a[178:179], v14 offset:33792
    v_mfma_f32_32x32x16_bf16 v[100:115], v[64:67], a[224:227], v[100:115]
    s_xor_b32 s9, s64, 5120
    buffer_load_dwordx4 a[24:27], v28, s[36:39], s9 offen sc1
    s_waitcnt lgkmcnt(6)
    s_lshl_b32 s89, s56, 2
    s_add_u32 s89, s89, s59
    s_lshl_b32 s89, s89, 3
    s_lshl_b32 s90, s58, 9
    s_add_u32 s89, s89, s90
    s_add_u32 s89, s89, 11599872
    v_mfma_f32_32x32x16_bf16 v[84:99], v[68:71], a[100:103], v[84:99]
    ds_read_b64_tr_b16 v[64:65], v23 offset:53248
    ds_read_b64_tr_b16 v[66:67], v23 offset:53760
    ds_read_b64_tr_b16 a[180:181], v15 offset:32768
    ds_read_b64_tr_b16 a[182:183], v15 offset:33792
    s_waitcnt vmcnt(17)
    s_mov_b64 exec, 1
    buffer_store_dwordx2 v[250:251], v246, s[36:39], s89 offen sc1
    s_mov_b64 exec, -1
    v_mfma_f32_32x32x16_bf16 v[100:115], v[68:71], a[228:231], v[100:115]
    s_xor_b32 s9, s64, 136192
    buffer_load_dwordx4 a[28:31], v28, s[36:39], s9 offen sc1
    s_waitcnt lgkmcnt(6)
    s_barrier
    v_mfma_f32_16x16x32_bf16 v[56:59], v[40:43], v[60:63], v[56:59]
    v_mfma_f32_32x32x16_bf16 v[84:99], v[60:63], a[104:107], v[84:99]
    ds_read_b64_tr_b16 v[68:69], v20 offset:32768
    ds_read_b64_tr_b16 v[70:71], v20 offset:33280
    s_xor_b32 s9, s64, 6144
    buffer_load_dwordx4 a[144:147], v28, s[36:39], s9 offen sc1
    ds_read_b64_tr_b16 a[184:185], v16 offset:16384
    ds_read_b64_tr_b16 a[186:187], v16 offset:17408
    v_mfma_f32_32x32x16_bf16 v[100:115], v[60:63], a[232:235], v[100:115]
    s_xor_b32 s9, s64, 137216
    buffer_load_dwordx4 a[148:151], v28, s[36:39], s9 offen sc1
    s_waitcnt lgkmcnt(6)
    v_mfma_f32_32x32x16_bf16 v[84:99], v[64:67], a[108:111], v[84:99]
    ds_read_b64_tr_b16 v[60:61], v21 offset:32768
    ds_read_b64_tr_b16 v[62:63], v21 offset:33280
    ds_read_b64_tr_b16 a[188:189], v17 offset:16384
    ds_read_b64_tr_b16 a[190:191], v17 offset:17408
    v_mfma_f32_32x32x16_bf16 v[100:115], v[64:67], a[236:239], v[100:115]
    s_xor_b32 s9, s64, 7168
    buffer_load_dwordx4 a[152:155], v28, s[36:39], s9 offen sc1
    v_cndmask_b32 v37, v56, v57, s[16:17]
    ds_write_b32 v26, v37
    s_waitcnt lgkmcnt(7)
    v_mfma_f32_16x16x32_bf16 v[56:59], v[40:43], v[68:71], v[56:59]
    v_mfma_f32_32x32x16_bf16 v[84:99], v[68:71], a[112:115], v[84:99]
    ds_read_b64_tr_b16 v[64:65], v20 offset:36864
    ds_read_b64_tr_b16 v[66:67], v20 offset:37376
    s_xor_b32 s9, s64, 138240
    buffer_load_dwordx4 a[156:159], v28, s[36:39], s9 offen sc1
    v_mfma_f32_32x32x16_bf16 v[100:115], v[68:71], a[240:243], v[100:115]
    s_add_u32 m0, s8, 106496
    s_xor_b32 s88, s12, 98304
    s_add_u32 s88, s88, s98
    buffer_load_dwordx4 v10, s[48:51], s88 offen lds
    s_waitcnt lgkmcnt(5)
    v_mfma_f32_16x16x32_bf16 v[56:59], v[40:43], v[60:63], v[56:59]
    v_mfma_f32_32x32x16_bf16 v[84:99], v[60:63], a[116:119], v[84:99]
    ds_read_b64_tr_b16 v[68:69], v21 offset:36864
    ds_read_b64_tr_b16 v[70:71], v21 offset:37376
    buffer_load_dwordx4 v11, s[48:51], s88 offen offset:1024 lds
    v_mfma_f32_32x32x16_bf16 v[100:115], v[60:63], a[244:247], v[100:115]
    s_waitcnt lgkmcnt(2)
    s_barrier
    v_mfma_f32_16x16x32_bf16 v[56:59], v[40:43], v[64:67], v[56:59]
    v_mfma_f32_32x32x16_bf16 v[84:99], v[64:67], a[120:123], v[84:99]
    s_add_u32 m0, s8, 122880
    s_xor_b32 s88, s12, 114688
    s_add_u32 s88, s88, s98
    buffer_load_dwordx4 v10, s[48:51], s88 offen lds
    v_mfma_f32_32x32x16_bf16 v[100:115], v[64:67], a[248:251], v[100:115]
    ds_read_b32 v36, v27
    buffer_load_dwordx4 v11, s[48:51], s88 offen offset:1024 lds
    s_waitcnt lgkmcnt(1)
    v_mfma_f32_16x16x32_bf16 v[56:59], v[40:43], v[68:71], v[56:59]
    v_mfma_f32_32x32x16_bf16 v[84:99], v[68:71], a[124:127], v[84:99]
    s_add_u32 m0, s8, 65536
    s_xor_b32 s88, s12, 131072
    s_add_u32 s88, s88, s97
    buffer_load_dwordx4 v10, s[44:47], s88 offen lds
    v_mfma_f32_32x32x16_bf16 v[100:115], v[68:71], a[252:255], v[100:115]
    buffer_load_dwordx4 v11, s[44:47], s88 offen offset:1024 lds
    s_waitcnt lgkmcnt(0)
    v_cndmask_b32 v38, v56, v57, s[16:17]
    v_add_f32 v38, v38, v36
    v_cvt_pk_bf16_f32 v212, -v38, -v38
    v_and_b32 v212, 0xffff0000, v212
    v_sub_f32 v212, -v38, v212
    v_cvt_pk_bf16_f32 v212, -v38, v212
    v_cndmask_b32 v80, v212, 0, s[18:19]
    s_nop 1
    v_mfma_f32_32x32x16_bf16 v[84:99], v[80:83], v[72:75], v[84:99]
    v_mfma_f32_32x32x16_bf16 v[100:115], v[80:83], v[76:79], v[100:115]
    s_nop 10
    v_pk_mul_f32 v[84:85], v[84:85], v[34:35] op_sel:[0,0] op_sel_hi:[1,0]
    v_pk_mul_f32 v[86:87], v[86:87], v[34:35] op_sel:[0,0] op_sel_hi:[1,0]
    v_pk_mul_f32 v[88:89], v[88:89], v[34:35] op_sel:[0,0] op_sel_hi:[1,0]
    v_pk_mul_f32 v[90:91], v[90:91], v[34:35] op_sel:[0,0] op_sel_hi:[1,0]
    v_pk_mul_f32 v[92:93], v[92:93], v[34:35] op_sel:[0,0] op_sel_hi:[1,0]
    v_pk_mul_f32 v[94:95], v[94:95], v[34:35] op_sel:[0,0] op_sel_hi:[1,0]
    v_pk_mul_f32 v[96:97], v[96:97], v[34:35] op_sel:[0,0] op_sel_hi:[1,0]
    v_pk_mul_f32 v[98:99], v[98:99], v[34:35] op_sel:[0,0] op_sel_hi:[1,0]
    v_cvt_pk_bf16_f32 v196, v84, v85
    v_cvt_pk_bf16_f32 v197, v86, v87
    v_cvt_pk_bf16_f32 v198, v88, v89
    v_cvt_pk_bf16_f32 v199, v90, v91
    v_pk_max_i16 v196, v196, 0
    v_pk_max_i16 v197, v197, 0
    v_pk_max_i16 v198, v198, 0
    v_pk_max_i16 v199, v199, 0
    s_mul_i32 s9, s10, 131072
    s_add_u32 s9, s9, s96
    buffer_store_dwordx4 v[196:199], v28, s[36:39], s9 offen sc1
    v_cvt_pk_bf16_f32 v200, v92, v93
    v_cvt_pk_bf16_f32 v201, v94, v95
    v_cvt_pk_bf16_f32 v202, v96, v97
    v_cvt_pk_bf16_f32 v203, v98, v99
    v_pk_max_i16 v200, v200, 0
    v_pk_max_i16 v201, v201, 0
    v_pk_max_i16 v202, v202, 0
    v_pk_max_i16 v203, v203, 0
    buffer_store_dwordx4 v[200:203], v28, s[36:39], s9 offen offset:1024 sc1
    v_pk_mul_f32 v[100:101], v[100:101], v[34:35] op_sel:[0,1] op_sel_hi:[1,1]
    v_pk_mul_f32 v[102:103], v[102:103], v[34:35] op_sel:[0,1] op_sel_hi:[1,1]
    v_pk_mul_f32 v[104:105], v[104:105], v[34:35] op_sel:[0,1] op_sel_hi:[1,1]
    v_pk_mul_f32 v[106:107], v[106:107], v[34:35] op_sel:[0,1] op_sel_hi:[1,1]
    v_pk_mul_f32 v[108:109], v[108:109], v[34:35] op_sel:[0,1] op_sel_hi:[1,1]
    v_pk_mul_f32 v[110:111], v[110:111], v[34:35] op_sel:[0,1] op_sel_hi:[1,1]
    v_pk_mul_f32 v[112:113], v[112:113], v[34:35] op_sel:[0,1] op_sel_hi:[1,1]
    v_pk_mul_f32 v[114:115], v[114:115], v[34:35] op_sel:[0,1] op_sel_hi:[1,1]
    v_cvt_pk_bf16_f32 v204, v100, v101
    v_cvt_pk_bf16_f32 v205, v102, v103
    v_cvt_pk_bf16_f32 v206, v104, v105
    v_cvt_pk_bf16_f32 v207, v106, v107
    v_pk_max_i16 v204, v204, 0
    v_pk_max_i16 v205, v205, 0
    v_pk_max_i16 v206, v206, 0
    v_pk_max_i16 v207, v207, 0
    s_mul_i32 s9, s11, 131072
    s_add_u32 s9, s9, s96
    buffer_store_dwordx4 v[204:207], v28, s[36:39], s9 offen sc1
    v_cvt_pk_bf16_f32 v208, v108, v109
    v_cvt_pk_bf16_f32 v209, v110, v111
    v_cvt_pk_bf16_f32 v210, v112, v113
    v_cvt_pk_bf16_f32 v211, v114, v115
    v_pk_max_i16 v208, v208, 0
    v_pk_max_i16 v209, v209, 0
    v_pk_max_i16 v210, v210, 0
    v_pk_max_i16 v211, v211, 0
    buffer_store_dwordx4 v[208:211], v28, s[36:39], s9 offen offset:1024 sc1
    s_waitcnt lgkmcnt(0)
    s_barrier
    s_waitcnt vmcnt(25)
    v_mfma_f32_32x32x16_bf16 v[116:131], a[32:35], a[0:3], 0
    v_mfma_f32_32x32x16_bf16 v[148:163], a[36:39], a[0:3], 0
    v_mfma_f32_32x32x16_bf16 v[132:147], a[32:35], a[4:7], 0
    v_mfma_f32_32x32x16_bf16 v[164:179], a[36:39], a[4:7], 0
    s_add_u32 m0, s8, 16384
    s_xor_b32 s88, s12, 147456
    s_add_u32 s88, s88, s97
    buffer_load_dwordx4 v10, s[44:47], s88 offen lds
    s_waitcnt vmcnt(24)
    v_mfma_f32_32x32x16_bf16 v[116:131], a[40:43], a[8:11], v[116:131]
    buffer_load_dwordx4 v11, s[44:47], s88 offen offset:1024 lds
    v_mfma_f32_32x32x16_bf16 v[148:163], a[44:47], a[8:11], v[148:163]
    v_mfma_f32_32x32x16_bf16 v[132:147], a[40:43], a[12:15], v[132:147]
    v_mfma_f32_32x32x16_bf16 v[164:179], a[44:47], a[12:15], v[164:179]
    s_add_u32 m0, s8, 73728
    s_xor_b32 s88, s12, 163840
    s_add_u32 s88, s88, s97
    buffer_load_dwordx4 v10, s[44:47], s88 offen lds
    s_waitcnt vmcnt(24)
    v_mfma_f32_32x32x16_bf16 v[116:131], a[160:163], a[128:131], v[116:131]
    buffer_load_dwordx4 v11, s[44:47], s88 offen offset:1024 lds
    v_mfma_f32_32x32x16_bf16 v[148:163], a[164:167], a[128:131], v[148:163]
    v_mfma_f32_32x32x16_bf16 v[132:147], a[160:163], a[132:135], v[132:147]
    v_mfma_f32_32x32x16_bf16 v[164:179], a[164:167], a[132:135], v[164:179]
    s_add_u32 m0, s8, 57344
    s_xor_b32 s88, s12, 180224
    s_add_u32 s88, s88, s97
    buffer_load_dwordx4 v10, s[44:47], s88 offen lds
    s_waitcnt vmcnt(24)
    v_mfma_f32_32x32x16_bf16 v[116:131], a[168:171], a[136:139], v[116:131]
    buffer_load_dwordx4 v11, s[44:47], s88 offen offset:1024 lds
    v_mfma_f32_32x32x16_bf16 v[148:163], a[172:175], a[136:139], v[148:163]
    v_mfma_f32_32x32x16_bf16 v[132:147], a[168:171], a[140:143], v[132:147]
    v_mfma_f32_32x32x16_bf16 v[164:179], a[172:175], a[140:143], v[164:179]
    s_add_u32 m0, s8, 24576
    s_xor_b32 s88, s12, 196608
    s_add_u32 s88, s88, s97
    buffer_load_dwordx4 v10, s[44:47], s88 offen lds
    buffer_load_dwordx2 v[248:249], v244, s[36:39], s2 offen sc1
    buffer_load_dwordx4 v[48:51], v28, s[36:39], s3 offen sc1
    s_waitcnt vmcnt(26)
    v_mfma_f32_32x32x16_bf16 v[116:131], a[48:51], a[16:19], v[116:131]
    buffer_load_dwordx4 v11, s[44:47], s88 offen offset:1024 lds
    v_mfma_f32_32x32x16_bf16 v[148:163], a[52:55], a[16:19], v[148:163]
    v_mfma_f32_32x32x16_bf16 v[132:147], a[48:51], a[20:23], v[132:147]
    v_mfma_f32_32x32x16_bf16 v[164:179], a[52:55], a[20:23], v[164:179]
    s_add_u32 m0, s8, 90112
    s_xor_b32 s88, s12, 212992
    s_add_u32 s88, s88, s97
    buffer_load_dwordx4 v10, s[44:47], s88 offen lds
    s_waitcnt vmcnt(25)
    v_mfma_f32_32x32x16_bf16 v[116:131], a[56:59], a[24:27], v[116:131]
    buffer_load_dwordx4 v11, s[44:47], s88 offen offset:1024 lds
    v_mfma_f32_32x32x16_bf16 v[148:163], a[60:63], a[24:27], v[148:163]
    v_mfma_f32_32x32x16_bf16 v[132:147], a[56:59], a[28:31], v[132:147]
    v_mfma_f32_32x32x16_bf16 v[164:179], a[60:63], a[28:31], v[164:179]
    s_add_u32 m0, s8, 98304
    s_xor_b32 s88, s12, 229376
    s_add_u32 s88, s88, s97
    buffer_load_dwordx4 v10, s[44:47], s88 offen lds
    s_waitcnt vmcnt(25)
    v_mfma_f32_32x32x16_bf16 v[116:131], a[176:179], a[144:147], v[116:131]
    buffer_load_dwordx4 v11, s[44:47], s88 offen offset:1024 lds
    v_mfma_f32_32x32x16_bf16 v[148:163], a[180:183], a[144:147], v[148:163]
    v_mfma_f32_32x32x16_bf16 v[132:147], a[176:179], a[148:151], v[132:147]
    v_mfma_f32_32x32x16_bf16 v[164:179], a[180:183], a[148:151], v[164:179]
    s_add_u32 m0, s8, 114688
    s_xor_b32 s88, s12, 245760
    s_add_u32 s88, s88, s97
    buffer_load_dwordx4 v10, s[44:47], s88 offen lds
    s_lshl_b32 s89, s56, 1
    s_add_u32 s89, s89, s60
    s_lshl_b32 s89, s89, 2
    s_lshr_b32 s90, s58, 1
    s_add_u32 s89, s89, s90
    s_lshl_b32 s89, s89, 4
    s_and_b32 s90, s58, 1
    s_lshl_b32 s90, s90, 1
    s_add_u32 s89, s89, s90
    s_add_u32 s89, s89, s61
    s_add_u32 s89, s89, 8
    s_lshl_b32 s89, s89, 3
    s_add_u32 s89, s89, 11534336
    buffer_load_dwordx4 v11, s[44:47], s88 offen offset:1024 lds
    s_waitcnt vmcnt(16)
    s_mov_b64 exec, 1
    buffer_store_dwordx2 v[250:251], v246, s[36:39], s89 offen sc1
    s_mov_b64 exec, -1
    v_mfma_f32_32x32x16_bf16 v[116:131], a[184:187], a[152:155], v[116:131]
    ds_read_b64_tr_b16 v[72:73], v16 offset:24576
    ds_read_b64_tr_b16 v[74:75], v16 offset:25600
    v_mfma_f32_32x32x16_bf16 v[148:163], a[188:191], a[152:155], v[148:163]
    ds_read_b64_tr_b16 v[76:77], v17 offset:24576
    ds_read_b64_tr_b16 v[78:79], v17 offset:25600
    v_mfma_f32_32x32x16_bf16 v[132:147], a[184:187], a[156:159], v[132:147]
    v_mfma_f32_32x32x16_bf16 v[164:179], a[188:191], a[156:159], v[164:179]
    s_add_u32 m0, s8, 147456
    s_add_u32 s88, s97, 262144
    buffer_load_dwordx4 v10, s[44:47], s88 offen lds
    s_waitcnt vmcnt(10)
    s_mov_b32 s90, 0
    v_cmp_eq_u64 vcc, v[248:249], s[92:93]
    s_nop 1
    s_and_b32 vcc_lo, vcc_lo, 240
    s_cmp_eq_u32 vcc_lo, 240
    s_cbranch_scc1 L_POK2
L_PL2:
    s_sleep 2
    buffer_load_dwordx2 v[248:249], v244, s[36:39], s2 offen sc1
    s_waitcnt vmcnt(0)
    s_add_u32 s90, s90, 1
    s_cmp_gt_u32 s90, 200000
    s_cbranch_scc1 L_POK2
    v_cmp_eq_u64 vcc, v[248:249], s[92:93]
    s_nop 1
    s_and_b32 vcc_lo, vcc_lo, 240
    s_cmp_eq_u32 vcc_lo, 240
    s_cbranch_scc0 L_PL2
L_POK2:
    s_nop 4
    s_waitcnt vmcnt(9)
    s_mov_b32 s90, 0
    v_cmp_eq_u64 vcc, v[48:49], s[92:93]
    v_cmp_eq_u64 s[20:21], v[50:51], s[92:93]
    s_nop 1
    s_and_b64 vcc, vcc, s[20:21]
    s_cmp_eq_u64 vcc, -1
    s_cbranch_scc1 L_POK3
L_PL3:
    s_sleep 2
    buffer_load_dwordx4 v[48:51], v28, s[36:39], s3 offen sc1
    s_waitcnt vmcnt(0)
    s_add_u32 s90, s90, 1
    s_cmp_gt_u32 s90, 200000
    s_cbranch_scc1 L_POK3
    v_cmp_eq_u64 vcc, v[48:49], s[92:93]
    v_cmp_eq_u64 s[20:21], v[50:51], s[92:93]
    s_nop 1
    s_and_b64 vcc, vcc, s[20:21]
    s_cmp_eq_u64 vcc, -1
    s_cbranch_scc0 L_PL3
L_POK3:
    s_nop 4
    buffer_load_dwordx4 v11, s[44:47], s88 offen offset:1024 lds
    s_xor_b32 s9, s65, 0
    s_mul_i32 s9, s9, 1088
    s_add_u32 s9, s9, s91
    buffer_load_dwordx4 v[180:183], v18, s[36:39], s9 offen offset:0 sc1
    buffer_load_dwordx4 v[184:187], v4, s[36:39], s9 offen offset:32 sc1
    s_xor_b32 s9, s101, 0
    buffer_load_dwordx4 a[64:67], v28, s[36:39], s9 offen sc1
    s_xor_b32 s9, s101, 32768
    buffer_load_dwordx4 a[68:71], v28, s[36:39], s9 offen sc1
    s_xor_b32 s9, s65, 1
    s_mul_i32 s9, s9, 1088
    s_add_u32 s9, s9, s91
    buffer_load_dwordx4 v[188:191], v18, s[36:39], s9 offen offset:0 sc1
    buffer_load_dwordx4 v[192:195], v4, s[36:39], s9 offen offset:32 sc1
    s_xor_b32 s9, s101, 1024
    buffer_load_dwordx4 a[72:75], v28, s[36:39], s9 offen sc1
    s_xor_b32 s9, s101, 33792
    buffer_load_dwordx4 a[76:79], v28, s[36:39], s9 offen sc1
    s_xor_b32 s9, s65, 2
    s_mul_i32 s9, s9, 1088
    s_add_u32 s9, s9, s91
    buffer_load_dwordx4 v[212:215], v18, s[36:39], s9 offen offset:0 sc1
    buffer_load_dwordx4 v[216:219], v4, s[36:39], s9 offen offset:32 sc1
    s_xor_b32 s9, s101, 2048
    buffer_load_dwordx4 a[192:195], v28, s[36:39], s9 offen sc1
    s_xor_b32 s9, s101, 34816
    buffer_load_dwordx4 a[196:199], v28, s[36:39], s9 offen sc1
    s_xor_b32 s9, s65, 3
    s_mul_i32 s9, s9, 1088
    s_add_u32 s9, s9, s91
    buffer_load_dwordx4 v[220:223], v18, s[36:39], s9 offen offset:0 sc1
    buffer_load_dwordx4 v[224:227], v4, s[36:39], s9 offen offset:32 sc1
    s_xor_b32 s9, s101, 3072
    buffer_load_dwordx4 a[200:203], v28, s[36:39], s9 offen sc1
    s_xor_b32 s9, s101, 35840
    buffer_load_dwordx4 a[204:207], v28, s[36:39], s9 offen sc1
    s_xor_b32 s9, s65, 4
    s_mul_i32 s9, s9, 1088
    s_add_u32 s9, s9, s91
    buffer_load_dwordx4 v[228:231], v18, s[36:39], s9 offen offset:0 sc1
    buffer_load_dwordx4 v[232:235], v4, s[36:39], s9 offen offset:32 sc1
    s_xor_b32 s9, s101, 4096
    buffer_load_dwordx4 a[80:83], v28, s[36:39], s9 offen sc1
    s_xor_b32 s9, s101, 36864
    buffer_load_dwordx4 a[84:87], v28, s[36:39], s9 offen sc1
    s_waitcnt vmcnt(16)
    v_cvt_pk_bf16_f32 v180, v180, v181
    v_cvt_pk_bf16_f32 v181, v182, v183
    v_cvt_pk_bf16_f32 v182, v184, v185
    v_cvt_pk_bf16_f32 v183, v186, v187
    s_nop 1
    v_mfma_f32_32x32x16_bf16 v[84:99], v[180:183], a[64:67], 0
    v_mfma_f32_32x32x16_bf16 v[100:115], v[180:183], a[68:71], 0
    s_waitcnt vmcnt(14)
    v_cvt_pk_bf16_f32 v188, v188, v189
    v_cvt_pk_bf16_f32 v189, v190, v191
    v_cvt_pk_bf16_f32 v190, v192, v193
    v_cvt_pk_bf16_f32 v191, v194, v195
    s_nop 5
    v_add_f32 v92, s13, v92
    v_rcp_f32 v92, v92
    s_nop 0
    v_mul_f32 v84, v84, v92
    v_mul_f32 v85, v85, v92
    v_mul_f32 v86, v86, v92
    v_mul_f32 v87, v87, v92
    v_mul_f32 v88, v88, v92
    v_mul_f32 v89, v89, v92
    v_mul_f32 v90, v90, v92
    v_mul_f32 v91, v91, v92
    v_cvt_pk_bf16_f32 v196, v84, v85
    v_cvt_pk_bf16_f32 v197, v86, v87
    v_cvt_pk_bf16_f32 v198, v88, v89
    v_cvt_pk_bf16_f32 v199, v90, v91
    s_waitcnt vmcnt(12) lgkmcnt(0)
    v_mfma_f32_32x32x16_bf16 v[84:99], v[188:191], a[72:75], 0
    ds_read_b64_tr_b16 v[56:57], v12 offset:0
    ds_read_b64_tr_b16 v[58:59], v12 offset:1024
    v_add_f32 v108, s13, v108
    v_rcp_f32 v108, v108
    s_nop 0
    v_mul_f32 v100, v100, v108
    v_mul_f32 v101, v101, v108
    v_mul_f32 v102, v102, v108
    v_mfma_f32_32x32x16_bf16 v[116:131], v[72:75], v[196:199], v[116:131]
    ds_read_b64_tr_b16 v[60:61], v13 offset:0
    ds_read_b64_tr_b16 v[62:63], v13 offset:1024
    v_mul_f32 v103, v103, v108
    v_mul_f32 v104, v104, v108
    v_mul_f32 v105, v105, v108
    v_mul_f32 v106, v106, v108
    v_mul_f32 v107, v107, v108
    v_cvt_pk_bf16_f32 v200, v100, v101
    v_mfma_f32_32x32x16_bf16 v[148:163], v[76:79], v[196:199], v[148:163]
    s_waitcnt vmcnt(10)
    buffer_load_dwordx2 v[248:249], v244, s[36:39], s2 offen sc1
    v_cvt_pk_bf16_f32 v201, v102, v103
    v_cvt_pk_bf16_f32 v202, v104, v105
    v_cvt_pk_bf16_f32 v203, v106, v107
    v_add_f32 v92, s13, v92
    v_rcp_f32 v92, v92
    v_mfma_f32_32x32x16_bf16 v[100:115], v[188:191], a[76:79], 0
    s_xor_b32 s9, s65, 5
    s_mul_i32 s9, s9, 1088
    s_add_u32 s9, s9, s91
    buffer_load_dwordx4 v[236:239], v18, s[36:39], s9 offen offset:0 sc1
    v_mul_f32 v84, v84, v92
    v_mul_f32 v85, v85, v92
    v_mul_f32 v86, v86, v92
    v_mul_f32 v87, v87, v92
    v_mul_f32 v88, v88, v92
    v_mul_f32 v89, v89, v92
    v_mfma_f32_32x32x16_bf16 v[132:147], v[72:75], v[200:203], v[132:147]
    buffer_load_dwordx4 v[240:243], v4, s[36:39], s9 offen offset:32 sc1
    v_mul_f32 v90, v90, v92
    v_mul_f32 v91, v91, v92
    v_cvt_pk_bf16_f32 v196, v84, v85
    v_cvt_pk_bf16_f32 v197, v86, v87
    v_cvt_pk_bf16_f32 v198, v88, v89
    v_cvt_pk_bf16_f32 v199, v90, v91
    v_mfma_f32_32x32x16_bf16 v[164:179], v[76:79], v[200:203], v[164:179]
    s_xor_b32 s9, s101, 5120
    buffer_load_dwordx4 a[88:91], v28, s[36:39], s9 offen sc1
    v_cvt_pk_bf16_f32 v212, v212, v213
    v_cvt_pk_bf16_f32 v213, v214, v215
    v_cvt_pk_bf16_f32 v214, v216, v217
    v_cvt_pk_bf16_f32 v215, v218, v219
    s_waitcnt vmcnt(12) lgkmcnt(0)
    s_nop 0
    v_mfma_f32_32x32x16_bf16 v[84:99], v[212:215], a[192:195], 0
    ds_read_b64_tr_b16 v[64:65], v14 offset:16384
    ds_read_b64_tr_b16 v[66:67], v14 offset:17408
    v_add_f32 v108, s13, v108
    v_rcp_f32 v108, v108
    s_nop 0
    v_mul_f32 v100, v100, v108
    v_mul_f32 v101, v101, v108
    v_mul_f32 v102, v102, v108
    v_mfma_f32_32x32x16_bf16 v[116:131], v[56:59], v[196:199], v[116:131]
    ds_read_b64_tr_b16 v[68:69], v15 offset:16384
    ds_read_b64_tr_b16 v[70:71], v15 offset:17408
    v_mul_f32 v103, v103, v108
    v_mul_f32 v104, v104, v108
    v_mul_f32 v105, v105, v108
    v_mul_f32 v106, v106, v108
    v_mul_f32 v107, v107, v108
    v_cvt_pk_bf16_f32 v200, v100, v101
    v_mfma_f32_32x32x16_bf16 v[148:163], v[60:63], v[196:199], v[148:163]
    s_waitcnt vmcnt(10)
    s_xor_b32 s9, s101, 37888
    buffer_load_dwordx4 a[92:95], v28, s[36:39], s9 offen sc1
    v_cvt_pk_bf16_f32 v201, v102, v103
    v_cvt_pk_bf16_f32 v202, v104, v105
    v_cvt_pk_bf16_f32 v203, v106, v107
    v_add_f32 v92, s13, v92
    v_rcp_f32 v92, v92
    v_mfma_f32_32x32x16_bf16 v[100:115], v[212:215], a[196:199], 0
    s_xor_b32 s9, s65, 6
    s_mul_i32 s9, s9, 1088
    s_add_u32 s9, s9, s91
    buffer_load_dwordx4 v[40:43], v18, s[36:39], s9 offen offset:0 sc1
    v_mul_f32 v84, v84, v92
    v_mul_f32 v85, v85, v92
    v_mul_f32 v86, v86, v92
    v_mul_f32 v87, v87, v92
    v_mul_f32 v88, v88, v92
    v_mul_f32 v89, v89, v92
    v_mfma_f32_32x32x16_bf16 v[132:147], v[56:59], v[200:203], v[132:147]
    buffer_load_dwordx4 v[44:47], v4, s[36:39], s9 offen offset:32 sc1
    v_mul_f32 v90, v90, v92
    v_mul_f32 v91, v91, v92
    v_cvt_pk_bf16_f32 v196, v84, v85
    v_cvt_pk_bf16_f32 v197, v86, v87
    v_cvt_pk_bf16_f32 v198, v88, v89
    v_cvt_pk_bf16_f32 v199, v90, v91
    v_mfma_f32_32x32x16_bf16 v[164:179], v[60:63], v[200:203], v[164:179]
    s_xor_b32 s9, s101, 6144
    buffer_load_dwordx4 a[208:211], v28, s[36:39], s9 offen sc1
    v_cvt_pk_bf16_f32 v220, v220, v221
    v_cvt_pk_bf16_f32 v221, v222, v223
    v_cvt_pk_bf16_f32 v222, v224, v225
    v_cvt_pk_bf16_f32 v223, v226, v227
    s_waitcnt vmcnt(12) lgkmcnt(0)
    s_nop 0
    v_mfma_f32_32x32x16_bf16 v[84:99], v[220:223], a[200:203], 0
    ds_read_b64_tr_b16 v[72:73], v12 offset:49152
    ds_read_b64_tr_b16 v[74:75], v12 offset:50176
    v_add_f32 v108, s13, v108
    v_rcp_f32 v108, v108
    s_nop 0
    v_mul_f32 v100, v100, v108
    v_mul_f32 v101, v101, v108
    v_mul_f32 v102, v102, v108
    v_mfma_f32_32x32x16_bf16 v[116:131], v[64:67], v[196:199], v[116:131]
    ds_read_b64_tr_b16 v[76:77], v13 offset:49152
    ds_read_b64_tr_b16 v[78:79], v13 offset:50176
    v_mul_f32 v103, v103, v108
    v_mul_f32 v104, v104, v108
    v_mul_f32 v105, v105, v108
    v_mul_f32 v106, v106, v108
    v_mul_f32 v107, v107, v108
    v_cvt_pk_bf16_f32 v200, v100, v101
    v_mfma_f32_32x32x16_bf16 v[148:163], v[68:71], v[196:199], v[148:163]
    s_waitcnt vmcnt(10)
    s_xor_b32 s9, s101, 38912
    buffer_load_dwordx4 a[212:215], v28, s[36:39], s9 offen sc1
    v_cvt_pk_bf16_f32 v201, v102, v103
    v_cvt_pk_bf16_f32 v202, v104, v105
    v_cvt_pk_bf16_f32 v203, v106, v107
    v_add_f32 v92, s13, v92
    v_rcp_f32 v92, v92
    v_mfma_f32_32x32x16_bf16 v[100:115], v[220:223], a[204:207], 0
    s_xor_b32 s9, s65, 7
    s_mul_i32 s9, s9, 1088
    s_add_u32 s9, s9, s91
    buffer_load_dwordx4 v[20:23], v18, s[36:39], s9 offen offset:0 sc1
    v_mul_f32 v84, v84, v92
    v_mul_f32 v85, v85, v92
    v_mul_f32 v86, v86, v92
    v_mul_f32 v87, v87, v92
    v_mul_f32 v88, v88, v92
    v_mul_f32 v89, v89, v92
    v_mfma_f32_32x32x16_bf16 v[132:147], v[64:67], v[200:203], v[132:147]
    buffer_load_dwordx4 v[24:27], v4, s[36:39], s9 offen offset:32 sc1
    v_mul_f32 v90, v90, v92
    v_mul_f32 v91, v91, v92
    v_cvt_pk_bf16_f32 v196, v84, v85
    v_cvt_pk_bf16_f32 v197, v86, v87
    v_cvt_pk_bf16_f32 v198, v88, v89
    v_cvt_pk_bf16_f32 v199, v90, v91
    v_mfma_f32_32x32x16_bf16 v[164:179], v[68:71], v[200:203], v[164:179]
    s_xor_b32 s9, s101, 7168
    buffer_load_dwordx4 a[216:219], v28, s[36:39], s9 offen sc1
    v_cvt_pk_bf16_f32 v228, v228, v229
    v_cvt_pk_bf16_f32 v229, v230, v231
    v_cvt_pk_bf16_f32 v230, v232, v233
    v_cvt_pk_bf16_f32 v231, v234, v235
    s_waitcnt vmcnt(11)
    s_mov_b32 s90, 0
    v_cmp_eq_u64 vcc, v[248:249], s[92:93]
    s_nop 1
    s_and_b32 vcc_lo, vcc_lo, 65280
    s_cmp_eq_u32 vcc_lo, 65280
    s_cbranch_scc1 L_POK4
L_PL4:
    s_sleep 2
    buffer_load_dwordx2 v[248:249], v244, s[36:39], s2 offen sc1
    s_waitcnt vmcnt(0)
    s_add_u32 s90, s90, 1
    s_cmp_gt_u32 s90, 200000
    s_cbranch_scc1 L_POK4
    v_cmp_eq_u64 vcc, v[248:249], s[92:93]
    s_nop 1
    s_and_b32 vcc_lo, vcc_lo, 65280
    s_cmp_eq_u32 vcc_lo, 65280
    s_cbranch_scc0 L_PL4
L_POK4:
    s_nop 4
    s_waitcnt lgkmcnt(0)
    v_mfma_f32_32x32x16_bf16 v[84:99], v[228:231], a[80:83], 0
    ds_read_b64_tr_b16 v[56:57], v12 offset:8192
    ds_read_b64_tr_b16 v[58:59], v12 offset:9216
    v_add_f32 v108, s13, v108
    v_rcp_f32 v108, v108
    s_nop 0
    v_mul_f32 v100, v100, v108
    v_mul_f32 v101, v101, v108
    v_mul_f32 v102, v102, v108
    v_mfma_f32_32x32x16_bf16 v[116:131], v[72:75], v[196:199], v[116:131]
    ds_read_b64_tr_b16 v[60:61], v13 offset:8192
    ds_read_b64_tr_b16 v[62:63], v13 offset:9216
    v_mul_f32 v103, v103, v108
    v_mul_f32 v104, v104, v108
    v_mul_f32 v105, v105, v108
    v_mul_f32 v106, v106, v108
    v_mul_f32 v107, v107, v108
    v_cvt_pk_bf16_f32 v200, v100, v101
    v_mfma_f32_32x32x16_bf16 v[148:163], v[76:79], v[196:199], v[148:163]
    s_waitcnt vmcnt(9)
    s_xor_b32 s9, s101, 39936
    buffer_load_dwordx4 a[220:223], v28, s[36:39], s9 offen sc1
    v_cvt_pk_bf16_f32 v201, v102, v103
    v_cvt_pk_bf16_f32 v202, v104, v105
    v_cvt_pk_bf16_f32 v203, v106, v107
    v_add_f32 v92, s13, v92
    v_rcp_f32 v92, v92
    v_mfma_f32_32x32x16_bf16 v[100:115], v[228:231], a[84:87], 0
    s_xor_b32 s9, s64, 8192
    buffer_load_dwordx4 a[96:99], v28, s[36:39], s9 offen sc1
    v_mul_f32 v84, v84, v92
    v_mul_f32 v85, v85, v92
    v_mul_f32 v86, v86, v92
    v_mul_f32 v87, v87, v92
    v_mul_f32 v88, v88, v92
    v_mul_f32 v89, v89, v92
    v_mfma_f32_32x32x16_bf16 v[132:147], v[72:75], v[200:203], v[132:147]
    s_xor_b32 s9, s64, 139264
    buffer_load_dwordx4 a[100:103], v28, s[36:39], s9 offen sc1
    v_mul_f32 v90, v90, v92
    v_mul_f32 v91, v91, v92
    v_cvt_pk_bf16_f32 v196, v84, v85
    v_cvt_pk_bf16_f32 v197, v86, v87
    v_cvt_pk_bf16_f32 v198, v88, v89
    v_cvt_pk_bf16_f32 v199, v90, v91
    v_mfma_f32_32x32x16_bf16 v[164:179], v[76:79], v[200:203], v[164:179]
    s_xor_b32 s9, s64, 9216
    buffer_load_dwordx4 a[104:107], v28, s[36:39], s9 offen sc1
    v_cvt_pk_bf16_f32 v236, v236, v237
    v_cvt_pk_bf16_f32 v237, v238, v239
    v_cvt_pk_bf16_f32 v238, v240, v241
    v_cvt_pk_bf16_f32 v239, v242, v243
    s_waitcnt vmcnt(11) lgkmcnt(0)
    s_nop 0
    v_mfma_f32_32x32x16_bf16 v[84:99], v[236:239], a[88:91], 0
    ds_read_b64_tr_b16 v[64:65], v12 offset:40960
    ds_read_b64_tr_b16 v[66:67], v12 offset:41984
    v_add_f32 v108, s13, v108
    v_rcp_f32 v108, v108
    s_nop 0
    v_mul_f32 v100, v100, v108
    v_mul_f32 v101, v101, v108
    v_mul_f32 v102, v102, v108
    v_mfma_f32_32x32x16_bf16 v[116:131], v[56:59], v[196:199], v[116:131]
    ds_read_b64_tr_b16 v[68:69], v13 offset:40960
    ds_read_b64_tr_b16 v[70:71], v13 offset:41984
    v_mul_f32 v103, v103, v108
    v_mul_f32 v104, v104, v108
    v_mul_f32 v105, v105, v108
    v_mul_f32 v106, v106, v108
    v_mul_f32 v107, v107, v108
    v_cvt_pk_bf16_f32 v200, v100, v101
    v_mfma_f32_32x32x16_bf16 v[148:163], v[60:63], v[196:199], v[148:163]
    s_waitcnt vmcnt(9)
    s_xor_b32 s9, s64, 140288
    buffer_load_dwordx4 a[108:111], v28, s[36:39], s9 offen sc1
    v_cvt_pk_bf16_f32 v201, v102, v103
    v_cvt_pk_bf16_f32 v202, v104, v105
    v_cvt_pk_bf16_f32 v203, v106, v107
    v_add_f32 v92, s13, v92
    v_rcp_f32 v92, v92
    v_mfma_f32_32x32x16_bf16 v[100:115], v[236:239], a[92:95], 0
    s_xor_b32 s9, s64, 10240
    buffer_load_dwordx4 a[224:227], v28, s[36:39], s9 offen sc1
    v_mul_f32 v84, v84, v92
    v_mul_f32 v85, v85, v92
    v_mul_f32 v86, v86, v92
    v_mul_f32 v87, v87, v92
    v_mul_f32 v88, v88, v92
    v_mul_f32 v89, v89, v92
    v_mfma_f32_32x32x16_bf16 v[132:147], v[56:59], v[200:203], v[132:147]
    s_xor_b32 s9, s64, 141312
    buffer_load_dwordx4 a[228:231], v28, s[36:39], s9 offen sc1
    v_mul_f32 v90, v90, v92
    v_mul_f32 v91, v91, v92
    v_cvt_pk_bf16_f32 v196, v84, v85
    v_cvt_pk_bf16_f32 v197, v86, v87
    v_cvt_pk_bf16_f32 v198, v88, v89
    v_cvt_pk_bf16_f32 v199, v90, v91
    v_mfma_f32_32x32x16_bf16 v[164:179], v[60:63], v[200:203], v[164:179]
    s_xor_b32 s9, s64, 11264
    buffer_load_dwordx4 a[232:235], v28, s[36:39], s9 offen sc1
    v_cvt_pk_bf16_f32 v40, v40, v41
    v_cvt_pk_bf16_f32 v41, v42, v43
    v_cvt_pk_bf16_f32 v42, v44, v45
    v_cvt_pk_bf16_f32 v43, v46, v47
    s_waitcnt vmcnt(11) lgkmcnt(0)
    s_nop 0
    v_mfma_f32_32x32x16_bf16 v[84:99], v[40:43], a[208:211], 0
    ds_read_b64_tr_b16 v[72:73], v14 offset:40960
    ds_read_b64_tr_b16 v[74:75], v14 offset:41984
    v_add_f32 v108, s13, v108
    v_rcp_f32 v108, v108
    s_nop 0
    v_mul_f32 v100, v100, v108
    v_mul_f32 v101, v101, v108
    v_mul_f32 v102, v102, v108
    v_mfma_f32_32x32x16_bf16 v[116:131], v[64:67], v[196:199], v[116:131]
    ds_read_b64_tr_b16 v[76:77], v15 offset:40960
    ds_read_b64_tr_b16 v[78:79], v15 offset:41984
    v_mul_f32 v103, v103, v108
    v_mul_f32 v104, v104, v108
    v_mul_f32 v105, v105, v108
    v_mul_f32 v106, v106, v108
    v_mul_f32 v107, v107, v108
    v_cvt_pk_bf16_f32 v200, v100, v101
    v_mfma_f32_32x32x16_bf16 v[148:163], v[68:71], v[196:199], v[148:163]
    s_waitcnt vmcnt(9)
    s_xor_b32 s9, s64, 142336
    buffer_load_dwordx4 a[236:239], v28, s[36:39], s9 offen sc1
    v_cvt_pk_bf16_f32 v201, v102, v103
    v_cvt_pk_bf16_f32 v202, v104, v105
    v_cvt_pk_bf16_f32 v203, v106, v107
    v_add_f32 v92, s13, v92
    v_rcp_f32 v92, v92
    v_mfma_f32_32x32x16_bf16 v[100:115], v[40:43], a[212:215], 0
    s_xor_b32 s9, s64, 12288
    buffer_load_dwordx4 a[112:115], v28, s[36:39], s9 offen sc1
    v_mul_f32 v84, v84, v92
    v_mul_f32 v85, v85, v92
    v_mul_f32 v86, v86, v92
    v_mul_f32 v87, v87, v92
    v_mul_f32 v88, v88, v92
    v_mul_f32 v89, v89, v92
    v_mfma_f32_32x32x16_bf16 v[132:147], v[64:67], v[200:203], v[132:147]
    s_xor_b32 s9, s64, 143360
    buffer_load_dwordx4 a[116:119], v28, s[36:39], s9 offen sc1
    v_mul_f32 v90, v90, v92
    v_mul_f32 v91, v91, v92
    v_cvt_pk_bf16_f32 v196, v84, v85
    v_cvt_pk_bf16_f32 v197, v86, v87
    v_cvt_pk_bf16_f32 v198, v88, v89
    v_cvt_pk_bf16_f32 v199, v90, v91
    v_mfma_f32_32x32x16_bf16 v[164:179], v[68:71], v[200:203], v[164:179]
    s_xor_b32 s9, s64, 13312
    buffer_load_dwordx4 a[120:123], v28, s[36:39], s9 offen sc1
    v_cvt_pk_bf16_f32 v20, v20, v21
    v_cvt_pk_bf16_f32 v21, v22, v23
    v_cvt_pk_bf16_f32 v22, v24, v25
    v_cvt_pk_bf16_f32 v23, v26, v27
    s_waitcnt vmcnt(11) lgkmcnt(0)
    s_nop 0
    v_mfma_f32_32x32x16_bf16 v[84:99], v[20:23], a[216:219], 0
    ds_read_b64_tr_b16 v[56:57], v14 offset:57344
    ds_read_b64_tr_b16 v[58:59], v14 offset:58368
    v_add_f32 v108, s13, v108
    v_rcp_f32 v108, v108
    s_nop 0
    v_mul_f32 v100, v100, v108
    v_mul_f32 v101, v101, v108
    v_mul_f32 v102, v102, v108
    v_mfma_f32_32x32x16_bf16 v[116:131], v[72:75], v[196:199], v[116:131]
    ds_read_b64_tr_b16 v[60:61], v15 offset:57344
    ds_read_b64_tr_b16 v[62:63], v15 offset:58368
    v_mul_f32 v103, v103, v108
    v_mul_f32 v104, v104, v108
    v_mul_f32 v105, v105, v108
    v_mul_f32 v106, v106, v108
    v_mul_f32 v107, v107, v108
    v_cvt_pk_bf16_f32 v200, v100, v101
    v_mfma_f32_32x32x16_bf16 v[148:163], v[76:79], v[196:199], v[148:163]
    s_xor_b32 s9, s64, 144384
    buffer_load_dwordx4 a[124:127], v28, s[36:39], s9 offen sc1
    v_cvt_pk_bf16_f32 v201, v102, v103
    v_cvt_pk_bf16_f32 v202, v104, v105
    v_cvt_pk_bf16_f32 v203, v106, v107
    v_add_f32 v92, s13, v92
    v_rcp_f32 v92, v92
    v_mfma_f32_32x32x16_bf16 v[100:115], v[20:23], a[220:223], 0
    s_xor_b32 s9, s64, 14336
    buffer_load_dwordx4 a[240:243], v28, s[36:39], s9 offen sc1
    v_mul_f32 v84, v84, v92
    v_mul_f32 v85, v85, v92
    v_mul_f32 v86, v86, v92
    v_mul_f32 v87, v87, v92
    v_mul_f32 v88, v88, v92
    v_mul_f32 v89, v89, v92
    v_mfma_f32_32x32x16_bf16 v[132:147], v[72:75], v[200:203], v[132:147]
    s_xor_b32 s9, s64, 15360
    buffer_load_dwordx4 a[248:251], v28, s[36:39], s9 offen sc1
    v_mul_f32 v90, v90, v92
    v_mul_f32 v91, v91, v92
    v_cvt_pk_bf16_f32 v196, v84, v85
    v_cvt_pk_bf16_f32 v197, v86, v87
    v_cvt_pk_bf16_f32 v198, v88, v89
    v_cvt_pk_bf16_f32 v199, v90, v91
    v_mfma_f32_32x32x16_bf16 v[164:179], v[76:79], v[200:203], v[164:179]
    s_add_u32 m0, s8, 32768
    s_add_u32 s88, s97, 278528
    buffer_load_dwordx4 v10, s[44:47], s88 offen lds
    s_waitcnt lgkmcnt(0)
    v_mfma_f32_32x32x16_bf16 v[116:131], v[56:59], v[196:199], v[116:131]
    ds_read_b64_tr_b16 v[64:65], v14 offset:0
    ds_read_b64_tr_b16 v[66:67], v14 offset:1024
    v_add_f32 v108, s13, v108
    v_rcp_f32 v108, v108
    s_nop 0
    v_mul_f32 v100, v100, v108
    v_mul_f32 v101, v101, v108
    v_mul_f32 v102, v102, v108
    v_mfma_f32_32x32x16_bf16 v[148:163], v[60:63], v[196:199], v[148:163]
    ds_read_b64_tr_b16 v[68:69], v15 offset:0
    ds_read_b64_tr_b16 v[70:71], v15 offset:1024
    v_mul_f32 v103, v103, v108
    v_mul_f32 v104, v104, v108
    v_mul_f32 v105, v105, v108
    v_mul_f32 v106, v106, v108
    v_mul_f32 v107, v107, v108
    v_cvt_pk_bf16_f32 v200, v100, v101
    v_cvt_pk_bf16_f32 v201, v102, v103
    v_cvt_pk_bf16_f32 v202, v104, v105
    v_cvt_pk_bf16_f32 v203, v106, v107
    s_nop 1
    v_mfma_f32_32x32x16_bf16 v[132:147], v[56:59], v[200:203], v[132:147]
    buffer_load_dwordx4 v11, s[44:47], s88 offen offset:1024 lds
    v_mfma_f32_32x32x16_bf16 v[164:179], v[60:63], v[200:203], v[164:179]
    s_add_u32 s9, s99, 16384
    buffer_load_dwordx4 a[0:3], v28, s[36:39], s9 offen sc1
    s_waitcnt vmcnt(15) lgkmcnt(0)
    v_mfma_f32_32x32x16_bf16 v[116:131], v[64:67], a[96:99], v[116:131]
    ds_read_b64_tr_b16 v[72:73], v12 offset:16384
    ds_read_b64_tr_b16 v[74:75], v12 offset:17408
    s_add_u32 m0, s8, 131072
    s_add_u32 s88, s97, 294912
    buffer_load_dwordx4 v10, s[44:47], s88 offen lds
    v_mfma_f32_32x32x16_bf16 v[148:163], v[68:71], a[96:99], v[148:163]
    ds_read_b64_tr_b16 v[76:77], v13 offset:16384
    ds_read_b64_tr_b16 v[78:79], v13 offset:17408
    buffer_load_dwordx4 v11, s[44:47], s88 offen offset:1024 lds
    v_mfma_f32_32x32x16_bf16 v[132:147], v[64:67], a[100:103], v[132:147]
    s_add_u32 s9, s99, 17408
    buffer_load_dwordx4 a[8:11], v28, s[36:39], s9 offen sc1
    v_mfma_f32_32x32x16_bf16 v[164:179], v[68:71], a[100:103], v[164:179]
    s_add_u32 m0, s8, 139264
    s_add_u32 s88, s97, 311296
    buffer_load_dwordx4 v10, s[44:47], s88 offen lds
    buffer_load_dwordx4 v[84:87], v19, s[24:27], s0 offen
    buffer_load_dwordx4 v[88:91], v19, s[24:27], s1 offen
    s_waitcnt vmcnt(19) lgkmcnt(0)
    v_mfma_f32_32x32x16_bf16 v[116:131], v[72:75], a[104:107], v[116:131]
    ds_read_b64_tr_b16 v[56:57], v14 offset:8192
    ds_read_b64_tr_b16 v[58:59], v14 offset:9216
    buffer_load_dwordx4 v11, s[44:47], s88 offen offset:1024 lds
    v_and_b32 v212, 31, v1
    v_lshrrev_b32 v213, 3, v212
    v_mfma_f32_32x32x16_bf16 v[148:163], v[76:79], a[104:107], v[148:163]
    ds_read_b64_tr_b16 v[60:61], v15 offset:8192
    ds_read_b64_tr_b16 v[62:63], v15 offset:9216
    s_add_u32 s9, s99, 18432
    buffer_load_dwordx4 a[128:131], v28, s[36:39], s9 offen sc1
    v_lshlrev_b32 v213, 13, v213
    v_mfma_f32_32x32x16_bf16 v[132:147], v[72:75], a[108:111], v[132:147]
    s_add_u32 m0, s8, 155648
    s_add_u32 s88, s97, 327680
    buffer_load_dwordx4 v10, s[44:47], s88 offen lds
    v_and_b32 v214, 7, v1
    v_lshl_add_u32 v213, v214, 8, v213
    v_mfma_f32_32x32x16_bf16 v[164:179], v[76:79], a[108:111], v[164:179]
    buffer_load_dwordx4 v11, s[44:47], s88 offen offset:1024 lds
    v_add_u32 v213, s8, v213
    v_lshrrev_b32 v215, 5, v1
    v_add_u32 v216, 0, v215
    v_xor_b32 v216, v216, v214
    s_waitcnt vmcnt(21) lgkmcnt(0)
    v_mfma_f32_32x32x16_bf16 v[116:131], v[56:59], a[224:227], v[116:131]
    ds_read_b64_tr_b16 v[64:65], v12 offset:57344
    ds_read_b64_tr_b16 v[66:67], v12 offset:58368
    s_add_u32 s9, s99, 19456
    buffer_load_dwordx4 a[136:139], v28, s[36:39], s9 offen sc1
    v_lshl_add_u32 v220, v216, 4, v213
    v_mfma_f32_32x32x16_bf16 v[148:163], v[60:63], a[224:227], v[148:163]
    ds_read_b64_tr_b16 v[68:69], v13 offset:57344
    ds_read_b64_tr_b16 v[70:71], v13 offset:58368
    s_add_u32 m0, s8, 0
    s_add_u32 s88, s97, 344064
    buffer_load_dwordx4 v10, s[44:47], s88 offen lds
    v_mfma_f32_32x32x16_bf16 v[132:147], v[56:59], a[228:231], v[132:147]
    buffer_load_dwordx4 v11, s[44:47], s88 offen offset:1024 lds
    v_add_u32 v216, 2, v215
    v_xor_b32 v216, v216, v214
    v_lshl_add_u32 v221, v216, 4, v213
    v_add_u32 v216, 4, v215
    v_mfma_f32_32x32x16_bf16 v[164:179], v[60:63], a[228:231], v[164:179]
    s_add_u32 s9, s100, 20480
    buffer_load_dwordx4 a[16:19], v28, s[36:39], s9 offen sc1
    v_xor_b32 v216, v216, v214
    v_lshl_add_u32 v222, v216, 4, v213
    v_add_u32 v216, 6, v215
    s_waitcnt vmcnt(23) lgkmcnt(0)
    v_mfma_f32_32x32x16_bf16 v[116:131], v[64:67], a[232:235], v[116:131]
    ds_read_b64_tr_b16 v[72:73], v12 offset:24576
    ds_read_b64_tr_b16 v[74:75], v12 offset:25600
    s_add_u32 s9, s100, 21504
    buffer_load_dwordx4 a[24:27], v28, s[36:39], s9 offen sc1
    v_xor_b32 v216, v216, v214
    v_mfma_f32_32x32x16_bf16 v[148:163], v[68:71], a[232:235], v[148:163]
    ds_read_b64_tr_b16 v[76:77], v13 offset:24576
    ds_read_b64_tr_b16 v[78:79], v13 offset:25600
    s_xor_b32 s9, s64, 145408
    buffer_load_dwordx4 a[244:247], v28, s[36:39], s9 offen sc1
    v_lshl_add_u32 v223, v216, 4, v213
    v_mfma_f32_32x32x16_bf16 v[132:147], v[64:67], a[236:239], v[132:147]
    ds_read_b64_tr_b16 v[180:181], v14 offset:32768
    ds_read_b64_tr_b16 v[182:183], v14 offset:33792
    s_xor_b32 s9, s64, 146432
    buffer_load_dwordx4 a[252:255], v28, s[36:39], s9 offen sc1
    v_lshrrev_b32 v212, 6, v0
    v_mfma_f32_32x32x16_bf16 v[164:179], v[68:71], a[236:239], v[164:179]
    ds_read_b64_tr_b16 v[184:185], v15 offset:32768
    ds_read_b64_tr_b16 v[186:187], v15 offset:33792
    s_add_u32 s9, s99, 147456
    buffer_load_dwordx4 a[4:7], v28, s[36:39], s9 offen sc1
    v_lshlrev_b32 v212, 13, v212
    s_waitcnt vmcnt(25) lgkmcnt(4)
    v_mfma_f32_32x32x16_bf16 v[116:131], v[72:75], a[112:115], v[116:131]
    ds_read_b64_tr_b16 v[56:57], v14 offset:24576
    ds_read_b64_tr_b16 v[58:59], v14 offset:25600
    s_add_u32 s9, s99, 148480
    buffer_load_dwordx4 a[12:15], v28, s[36:39], s9 offen sc1
    v_bfe_u32 v213, v0, 3, 3
    v_mfma_f32_32x32x16_bf16 v[148:163], v[76:79], a[112:115], v[148:163]
    ds_read_b64_tr_b16 v[60:61], v15 offset:24576
    ds_read_b64_tr_b16 v[62:63], v15 offset:25600
    s_add_u32 s9, s99, 149504
    buffer_load_dwordx4 a[132:135], v28, s[36:39], s9 offen sc1
    v_lshl_add_u32 v212, v213, 8, v212
    v_mfma_f32_32x32x16_bf16 v[132:147], v[72:75], a[116:119], v[132:147]
    ds_read_b64_tr_b16 v[188:189], v14 offset:49152
    ds_read_b64_tr_b16 v[190:191], v14 offset:50176
    s_add_u32 s9, s99, 150528
    buffer_load_dwordx4 a[140:143], v28, s[36:39], s9 offen sc1
    v_lshlrev_b32 v214, 1, v214
    v_mfma_f32_32x32x16_bf16 v[164:179], v[76:79], a[116:119], v[164:179]
    ds_read_b64_tr_b16 v[192:193], v15 offset:49152
    ds_read_b64_tr_b16 v[194:195], v15 offset:50176
    s_add_u32 s9, s100, 151552
    buffer_load_dwordx4 a[20:23], v28, s[36:39], s9 offen sc1
    v_xor_b32 v214, v214, v213
    s_waitcnt vmcnt(27) lgkmcnt(4)
    v_mfma_f32_32x32x16_bf16 v[116:131], v[56:59], a[120:123], v[116:131]
    ds_read_b64_tr_b16 v[196:197], v16 offset:16384
    ds_read_b64_tr_b16 v[198:199], v16 offset:17408
    s_add_u32 s9, s100, 152576
    buffer_load_dwordx4 a[28:31], v28, s[36:39], s9 offen sc1
    v_lshl_add_u32 v216, v214, 4, v212
    v_mfma_f32_32x32x16_bf16 v[148:163], v[60:63], a[120:123], v[148:163]
    ds_read_b64_tr_b16 v[200:201], v17 offset:16384
    ds_read_b64_tr_b16 v[202:203], v17 offset:17408
    v_xor_b32 v217, 16, v216
    v_mfma_f32_32x32x16_bf16 v[132:147], v[56:59], a[124:127], v[132:147]
    s_waitcnt vmcnt(24)
    ds_read_b64_tr_b16 v[204:205], v12 offset:32768
    ds_read_b64_tr_b16 v[206:207], v12 offset:33792
    v_mfma_f32_32x32x16_bf16 v[164:179], v[60:63], a[124:127], v[164:179]
    ds_read_b64_tr_b16 v[208:209], v13 offset:32768
    ds_read_b64_tr_b16 v[210:211], v13 offset:33792
    v_mfma_f32_32x32x16_bf16 v[116:131], v[180:183], a[240:243], v[116:131]
    s_waitcnt vmcnt(21)
    ds_read_b64_tr_b16 v[224:225], v16 offset:0
    ds_read_b64_tr_b16 v[226:227], v16 offset:1024
    v_mfma_f32_32x32x16_bf16 v[148:163], v[184:187], a[240:243], v[148:163]
    ds_read_b64_tr_b16 v[228:229], v17 offset:0
    ds_read_b64_tr_b16 v[230:231], v17 offset:1024
    s_waitcnt lgkmcnt(12)
    s_waitcnt vmcnt(17)
    v_mfma_f32_32x32x16_bf16 v[116:131], v[188:191], a[248:251], v[116:131]
    s_waitcnt vmcnt(16)
    ds_read_b64_tr_b16 v[232:233], v16 offset:8192
    ds_read_b64_tr_b16 v[234:235], v16 offset:9216
    v_lshlrev_b32 v92, 16, v84
    v_and_b32 v93, 0xffff0000, v84
    v_lshlrev_b32 v94, 16, v85
    v_and_b32 v95, 0xffff0000, v85
    v_mfma_f32_32x32x16_bf16 v[148:163], v[192:195], a[248:251], v[148:163]
    ds_read_b64_tr_b16 v[236:237], v17 offset:8192
    ds_read_b64_tr_b16 v[238:239], v17 offset:9216
    v_lshlrev_b32 v96, 16, v86
    v_and_b32 v97, 0xffff0000, v86
    v_lshlrev_b32 v98, 16, v87
    v_and_b32 v99, 0xffff0000, v87
    s_waitcnt lgkmcnt(12)
    v_mfma_f32_32x32x16_bf16 v[116:131], v[196:199], a[0:3], v[116:131]
    s_waitcnt vmcnt(13)
    ds_read_b64_tr_b16 v[40:41], v16 offset:24576
    ds_read_b64_tr_b16 v[42:43], v16 offset:25600
    v_lshlrev_b32 v100, 16, v88
    v_and_b32 v101, 0xffff0000, v88
    v_lshlrev_b32 v102, 16, v89
    v_and_b32 v103, 0xffff0000, v89
    v_mfma_f32_32x32x16_bf16 v[148:163], v[200:203], a[0:3], v[148:163]
    ds_read_b64_tr_b16 v[44:45], v17 offset:24576
    ds_read_b64_tr_b16 v[46:47], v17 offset:25600
    v_lshlrev_b32 v104, 16, v90
    v_and_b32 v105, 0xffff0000, v90
    v_lshlrev_b32 v106, 16, v91
    v_and_b32 v107, 0xffff0000, v91
    s_waitcnt lgkmcnt(12)
    v_mfma_f32_32x32x16_bf16 v[116:131], v[204:207], a[8:11], v[116:131]
    s_waitcnt vmcnt(10)
    ds_read_b64_tr_b16 v[48:49], v12 offset:0
    ds_read_b64_tr_b16 v[50:51], v12 offset:1024
    v_mfma_f32_32x32x16_bf16 v[148:163], v[208:211], a[8:11], v[148:163]
    ds_read_b64_tr_b16 v[52:53], v13 offset:0
    ds_read_b64_tr_b16 v[54:55], v13 offset:1024
    s_waitcnt lgkmcnt(12)
    v_mfma_f32_32x32x16_bf16 v[116:131], v[224:227], a[128:131], v[116:131]
    v_mfma_f32_32x32x16_bf16 v[148:163], v[228:231], a[128:131], v[148:163]
    s_waitcnt lgkmcnt(8)
    v_mfma_f32_32x32x16_bf16 v[116:131], v[232:235], a[136:139], v[116:131]
    v_mfma_f32_32x32x16_bf16 v[148:163], v[236:239], a[136:139], v[148:163]
    s_waitcnt vmcnt(9) lgkmcnt(4)
    v_mfma_f32_32x32x16_bf16 v[116:131], v[40:43], a[16:19], v[116:131]
    v_mfma_f32_32x32x16_bf16 v[148:163], v[44:47], a[16:19], v[148:163]
    s_waitcnt vmcnt(8) lgkmcnt(0)
    v_mfma_f32_32x32x16_bf16 v[116:131], v[48:51], a[24:27], v[116:131]
    v_mfma_f32_32x32x16_bf16 v[148:163], v[52:55], a[24:27], v[148:163]
    s_waitcnt vmcnt(7)
    v_mfma_f32_32x32x16_bf16 v[132:147], v[180:183], a[244:247], v[132:147]
    v_mfma_f32_32x32x16_bf16 v[164:179], v[184:187], a[244:247], v[164:179]
    s_waitcnt vmcnt(6)
    v_mfma_f32_32x32x16_bf16 v[132:147], v[188:191], a[252:255], v[132:147]
    s_nop 5
    ds_write_b128 v220, v[116:119] offset:0
    v_mfma_f32_32x32x16_bf16 v[164:179], v[192:195], a[252:255], v[164:179]
    ds_write_b128 v221, v[120:123] offset:0
    s_waitcnt vmcnt(5)
    v_mfma_f32_32x32x16_bf16 v[132:147], v[196:199], a[4:7], v[132:147]
    ds_write_b128 v222, v[124:127] offset:0
    v_mfma_f32_32x32x16_bf16 v[164:179], v[200:203], a[4:7], v[164:179]
    ds_write_b128 v223, v[128:131] offset:0
    s_waitcnt vmcnt(4)
    v_mfma_f32_32x32x16_bf16 v[132:147], v[204:207], a[12:15], v[132:147]
    ds_write_b128 v220, v[148:151] offset:128
    v_mfma_f32_32x32x16_bf16 v[164:179], v[208:211], a[12:15], v[164:179]
    ds_write_b128 v221, v[152:155] offset:128
    s_waitcnt vmcnt(3)
    v_mfma_f32_32x32x16_bf16 v[132:147], v[224:227], a[132:135], v[132:147]
    ds_write_b128 v222, v[156:159] offset:128
    v_mfma_f32_32x32x16_bf16 v[164:179], v[228:231], a[132:135], v[164:179]
    ds_write_b128 v223, v[160:163] offset:128
    s_waitcnt vmcnt(2)
    v_mfma_f32_32x32x16_bf16 v[132:147], v[232:235], a[140:143], v[132:147]
    v_mfma_f32_32x32x16_bf16 v[164:179], v[236:239], a[140:143], v[164:179]
    s_waitcnt vmcnt(1)
    v_mfma_f32_32x32x16_bf16 v[132:147], v[40:43], a[20:23], v[132:147]
    v_mfma_f32_32x32x16_bf16 v[164:179], v[44:47], a[20:23], v[164:179]
    s_waitcnt vmcnt(0)
    v_mfma_f32_32x32x16_bf16 v[132:147], v[48:51], a[28:31], v[132:147]
    v_mfma_f32_32x32x16_bf16 v[164:179], v[52:55], a[28:31], v[164:179]
    s_nop 10
    ds_write_b128 v220, v[132:135] offset:32768
    ds_write_b128 v221, v[136:139] offset:32768
    ds_write_b128 v222, v[140:143] offset:32768
    ds_write_b128 v223, v[144:147] offset:32768
    ds_write_b128 v220, v[164:167] offset:32896
    ds_write_b128 v221, v[168:171] offset:32896
    ds_write_b128 v222, v[172:175] offset:32896
    ds_write_b128 v223, v[176:179] offset:32896
    s_waitcnt lgkmcnt(0)
    s_barrier
    ds_read_b128 v[116:119], v216 offset:0
    ds_read_b128 v[120:123], v217 offset:0
    ds_read_b128 v[124:127], v216 offset:2048
    ds_read_b128 v[128:131], v217 offset:2048
    ds_read_b128 v[148:151], v216 offset:4096
    ds_read_b128 v[152:155], v217 offset:4096
    ds_read_b128 v[156:159], v216 offset:6144
    ds_read_b128 v[160:163], v217 offset:6144
    ds_read_b128 v[132:135], v216 offset:32768
    ds_read_b128 v[136:139], v217 offset:32768
    ds_read_b128 v[140:143], v216 offset:34816
    ds_read_b128 v[144:147], v217 offset:34816
    ds_read_b128 v[164:167], v216 offset:36864
    ds_read_b128 v[168:171], v217 offset:36864
    ds_read_b128 v[172:175], v216 offset:38912
    ds_read_b128 v[176:179], v217 offset:38912
    s_waitcnt lgkmcnt(8)
    v_pk_add_f32 v[116:117], v[116:117], v[124:125]
    v_pk_add_f32 v[148:149], v[148:149], v[156:157]
    v_pk_add_f32 v[118:119], v[118:119], v[126:127]
    v_pk_add_f32 v[150:151], v[150:151], v[158:159]
    v_pk_add_f32 v[120:121], v[120:121], v[128:129]
    v_pk_add_f32 v[152:153], v[152:153], v[160:161]
    v_pk_add_f32 v[122:123], v[122:123], v[130:131]
    v_pk_add_f32 v[154:155], v[154:155], v[162:163]
    v_pk_add_f32 v[116:117], v[116:117], v[92:93]
    v_pk_add_f32 v[118:119], v[118:119], v[94:95]
    v_pk_add_f32 v[120:121], v[120:121], v[96:97]
    v_pk_add_f32 v[122:123], v[122:123], v[98:99]
    v_pk_add_f32 v[116:117], v[116:117], v[148:149]
    v_pk_add_f32 v[118:119], v[118:119], v[150:151]
    v_pk_add_f32 v[120:121], v[120:121], v[152:153]
    v_pk_add_f32 v[122:123], v[122:123], v[154:155]
    v_cvt_pk_bf16_f32 v124, v116, v117
    v_cvt_pk_bf16_f32 v125, v118, v119
    v_cvt_pk_bf16_f32 v126, v120, v121
    v_cvt_pk_bf16_f32 v127, v122, v123
    buffer_store_dwordx4 v[124:127], v19, s[52:55], s0 offen
    s_waitcnt lgkmcnt(0)
    v_pk_add_f32 v[132:133], v[132:133], v[140:141]
    v_pk_add_f32 v[164:165], v[164:165], v[172:173]
    v_pk_add_f32 v[134:135], v[134:135], v[142:143]
    v_pk_add_f32 v[166:167], v[166:167], v[174:175]
    v_pk_add_f32 v[136:137], v[136:137], v[144:145]
    v_pk_add_f32 v[168:169], v[168:169], v[176:177]
    v_pk_add_f32 v[138:139], v[138:139], v[146:147]
    v_pk_add_f32 v[170:171], v[170:171], v[178:179]
    v_pk_add_f32 v[132:133], v[132:133], v[100:101]
    v_pk_add_f32 v[134:135], v[134:135], v[102:103]
    v_pk_add_f32 v[136:137], v[136:137], v[104:105]
    v_pk_add_f32 v[138:139], v[138:139], v[106:107]
    v_pk_add_f32 v[132:133], v[132:133], v[164:165]
    v_pk_add_f32 v[134:135], v[134:135], v[166:167]
    v_pk_add_f32 v[136:137], v[136:137], v[168:169]
    v_pk_add_f32 v[138:139], v[138:139], v[170:171]
    v_cvt_pk_bf16_f32 v140, v132, v133
    v_cvt_pk_bf16_f32 v141, v134, v135
    v_cvt_pk_bf16_f32 v142, v136, v137
    v_cvt_pk_bf16_f32 v143, v138, v139
    buffer_store_dwordx4 v[140:143], v19, s[52:55], s1 offen
    s_endpgm
L_TYPEB:
    v_mfma_f32_16x16x32_bf16 v[56:59], v[40:43], v[60:63], 0
    v_mfma_f32_4x4x4_16b_bf16 v[48:51], a[0:1], a[0:1], 0
    v_mfma_f32_4x4x4_16b_bf16 v[52:55], a[2:3], a[2:3], 0
    v_mfma_f32_16x16x32_bf16 v[44:47], v[40:43], a[0:3], 0
    ds_read_b64_tr_b16 v[68:69], v22 offset:4096
    ds_read_b64_tr_b16 v[70:71], v22 offset:4608
    v_mfma_f32_32x32x16_bf16 v[84:99], v[60:63], a[0:3], 0
    ds_read_b128 a[8:11], v14 offset:0
    s_add_u32 m0, s8, 81920
    s_add_u32 s88, s74, s4
    buffer_load_dwordx4 v6, s[28:31], s88 offen lds
    v_mfma_f32_32x32x16_bf16 v[100:115], v[60:63], a[128:131], 0
    ds_read_b128 a[136:139], v18 offset:0
    buffer_load_dwordx4 v7, s[28:31], s88 offen offset:1024 lds
    s_waitcnt lgkmcnt(4)
    v_mfma_f32_4x4x4_16b_bf16 v[48:51], a[4:5], a[4:5], v[48:51]
    v_mfma_f32_4x4x4_16b_bf16 v[52:55], a[6:7], a[6:7], v[52:55]
    v_mfma_f32_16x16x32_bf16 v[44:47], v[40:43], a[4:7], v[44:47]
    ds_read_b64_tr_b16 v[60:61], v23 offset:4096
    ds_read_b64_tr_b16 v[62:63], v23 offset:4608
    v_mfma_f32_32x32x16_bf16 v[84:99], v[64:67], a[4:7], v[84:99]
    ds_read_b128 a[12:15], v15 offset:0
    s_add_u32 m0, s7, 49152
    s_nop 0
    buffer_load_dwordx4 v2, s[24:27], s67 offen offset:0 lds
    v_mfma_f32_32x32x16_bf16 v[100:115], v[64:67], a[132:135], v[100:115]
    ds_read_b128 a[140:143], v19 offset:0
    buffer_load_dwordx4 v3, s[24:27], s67 offen offset:1024 lds
    s_waitcnt vmcnt(8) lgkmcnt(4)
    s_barrier
    v_mfma_f32_16x16x32_bf16 v[56:59], v[40:43], v[68:71], v[56:59]
    v_mfma_f32_4x4x4_16b_bf16 v[48:51], a[8:9], a[8:9], v[48:51]
    v_mfma_f32_4x4x4_16b_bf16 v[52:55], a[10:11], a[10:11], v[52:55]
    v_mfma_f32_16x16x32_bf16 v[44:47], v[40:43], a[8:11], v[44:47]
    ds_read_b64_tr_b16 v[64:65], v22 offset:8192
    ds_read_b64_tr_b16 v[66:67], v22 offset:8704
    v_mfma_f32_32x32x16_bf16 v[84:99], v[68:71], a[8:11], v[84:99]
    ds_read_b128 a[16:19], v12 offset:16384
    buffer_load_dwordx4 v4, s[24:27], s67 offen offset:2048 lds
    v_mfma_f32_32x32x16_bf16 v[100:115], v[68:71], a[136:139], v[100:115]
    ds_read_b128 a[144:147], v16 offset:16384
    buffer_load_dwordx4 v5, s[24:27], s67 offen offset:3072 lds
    s_waitcnt lgkmcnt(4)
    v_mfma_f32_4x4x4_16b_bf16 v[48:51], a[12:13], a[12:13], v[48:51]
    v_mfma_f32_4x4x4_16b_bf16 v[52:55], a[14:15], a[14:15], v[52:55]
    v_mfma_f32_16x16x32_bf16 v[44:47], v[40:43], a[12:15], v[44:47]
    ds_read_b64_tr_b16 v[68:69], v23 offset:8192
    ds_read_b64_tr_b16 v[70:71], v23 offset:8704
    v_mfma_f32_32x32x16_bf16 v[84:99], v[60:63], a[12:15], v[84:99]
    ds_read_b128 a[20:23], v13 offset:16384
    s_add_u32 m0, s8, 90112
    s_add_u32 s88, s75, s4
    buffer_load_dwordx4 v6, s[28:31], s88 offen lds
    v_mfma_f32_32x32x16_bf16 v[100:115], v[60:63], a[140:143], v[100:115]
    ds_read_b128 a[148:151], v17 offset:16384
    buffer_load_dwordx4 v7, s[28:31], s88 offen offset:1024 lds
    s_waitcnt lgkmcnt(4)
    v_mfma_f32_16x16x32_bf16 v[56:59], v[40:43], v[64:67], v[56:59]
    v_mfma_f32_4x4x4_16b_bf16 v[48:51], a[16:17], a[16:17], v[48:51]
    v_mfma_f32_4x4x4_16b_bf16 v[52:55], a[18:19], a[18:19], v[52:55]
    v_mfma_f32_16x16x32_bf16 v[44:47], v[40:43], a[16:19], v[44:47]
    ds_read_b64_tr_b16 v[60:61], v22 offset:12288
    ds_read_b64_tr_b16 v[62:63], v22 offset:12800
    v_mfma_f32_32x32x16_bf16 v[84:99], v[64:67], a[16:19], v[84:99]
    ds_read_b128 a[24:27], v14 offset:16384
    s_add_u32 m0, s7, 147456
    s_nop 0
    buffer_load_dwordx4 v2, s[24:27], s68 offen offset:0 lds
    v_mfma_f32_32x32x16_bf16 v[100:115], v[64:67], a[144:147], v[100:115]
    ds_read_b128 a[152:155], v18 offset:16384
    buffer_load_dwordx4 v3, s[24:27], s68 offen offset:1024 lds
    s_waitcnt lgkmcnt(4)
    v_mfma_f32_4x4x4_16b_bf16 v[48:51], a[20:21], a[20:21], v[48:51]
    v_mfma_f32_4x4x4_16b_bf16 v[52:55], a[22:23], a[22:23], v[52:55]
    v_mfma_f32_16x16x32_bf16 v[44:47], v[40:43], a[20:23], v[44:47]
    ds_read_b64_tr_b16 v[64:65], v23 offset:12288
    ds_read_b64_tr_b16 v[66:67], v23 offset:12800
    v_mfma_f32_32x32x16_bf16 v[84:99], v[68:71], a[20:23], v[84:99]
    ds_read_b128 a[28:31], v15 offset:16384
    buffer_load_dwordx4 v4, s[24:27], s68 offen offset:2048 lds
    v_mfma_f32_32x32x16_bf16 v[100:115], v[68:71], a[148:151], v[100:115]
    ds_read_b128 a[156:159], v19 offset:16384
    buffer_load_dwordx4 v5, s[24:27], s68 offen offset:3072 lds
    s_waitcnt vmcnt(10) lgkmcnt(4)
    s_barrier
    v_mfma_f32_16x16x32_bf16 v[56:59], v[40:43], v[60:63], v[56:59]
    v_mfma_f32_4x4x4_16b_bf16 v[48:51], a[24:25], a[24:25], v[48:51]
    v_mfma_f32_4x4x4_16b_bf16 v[52:55], a[26:27], a[26:27], v[52:55]
    v_mfma_f32_16x16x32_bf16 v[44:47], v[40:43], a[24:27], v[44:47]
    ds_read_b64_tr_b16 v[68:69], v22 offset:16384
    ds_read_b64_tr_b16 v[70:71], v22 offset:16896
    v_mfma_f32_32x32x16_bf16 v[84:99], v[60:63], a[24:27], v[84:99]
    ds_read_b128 a[32:35], v12 offset:32768
    s_add_u32 m0, s8, 98304
    s_add_u32 s88, s76, s4
    buffer_load_dwordx4 v6, s[28:31], s88 offen lds
    v_mfma_f32_32x32x16_bf16 v[100:115], v[60:63], a[152:155], v[100:115]
    ds_read_b128 a[160:163], v16 offset:32768
    buffer_load_dwordx4 v7, s[28:31], s88 offen offset:1024 lds
    s_waitcnt lgkmcnt(4)
    v_mfma_f32_4x4x4_16b_bf16 v[48:51], a[28:29], a[28:29], v[48:51]
    v_mfma_f32_4x4x4_16b_bf16 v[52:55], a[30:31], a[30:31], v[52:55]
    v_mfma_f32_16x16x32_bf16 v[44:47], v[40:43], a[28:31], v[44:47]
    ds_read_b64_tr_b16 v[60:61], v23 offset:16384
    ds_read_b64_tr_b16 v[62:63], v23 offset:16896
    v_mfma_f32_32x32x16_bf16 v[84:99], v[64:67], a[28:31], v[84:99]
    ds_read_b128 a[36:39], v13 offset:32768
    s_add_u32 m0, s7, 0
    s_nop 0
    buffer_load_dwordx4 v2, s[24:27], s69 offen offset:0 lds
    v_mfma_f32_32x32x16_bf16 v[100:115], v[64:67], a[156:159], v[100:115]
    ds_read_b128 a[164:167], v17 offset:32768
    buffer_load_dwordx4 v3, s[24:27], s69 offen offset:1024 lds
    s_waitcnt lgkmcnt(4)
    v_mfma_f32_16x16x32_bf16 v[56:59], v[40:43], v[68:71], v[56:59]
    v_mfma_f32_4x4x4_16b_bf16 v[48:51], a[32:33], a[32:33], v[48:51]
    v_mfma_f32_4x4x4_16b_bf16 v[52:55], a[34:35], a[34:35], v[52:55]
    v_mfma_f32_16x16x32_bf16 v[44:47], v[40:43], a[32:35], v[44:47]
    ds_read_b64_tr_b16 v[64:65], v22 offset:20480
    ds_read_b64_tr_b16 v[66:67], v22 offset:20992
    v_mfma_f32_32x32x16_bf16 v[84:99], v[68:71], a[32:35], v[84:99]
    ds_read_b128 a[40:43], v14 offset:32768
    buffer_load_dwordx4 v4, s[24:27], s69 offen offset:2048 lds
    v_mfma_f32_32x32x16_bf16 v[100:115], v[68:71], a[160:163], v[100:115]
    ds_read_b128 a[168:171], v18 offset:32768
    buffer_load_dwordx4 v5, s[24:27], s69 offen offset:3072 lds
    s_waitcnt lgkmcnt(4)
    v_mfma_f32_4x4x4_16b_bf16 v[48:51], a[36:37], a[36:37], v[48:51]
    v_mfma_f32_4x4x4_16b_bf16 v[52:55], a[38:39], a[38:39], v[52:55]
    v_mfma_f32_16x16x32_bf16 v[44:47], v[40:43], a[36:39], v[44:47]
    ds_read_b64_tr_b16 v[68:69], v23 offset:20480
    ds_read_b64_tr_b16 v[70:71], v23 offset:20992
    v_mfma_f32_32x32x16_bf16 v[84:99], v[60:63], a[36:39], v[84:99]
    ds_read_b128 a[44:47], v15 offset:32768
    s_add_u32 m0, s8, 106496
    s_add_u32 s88, s77, s4
    buffer_load_dwordx4 v6, s[28:31], s88 offen lds
    v_mfma_f32_32x32x16_bf16 v[100:115], v[60:63], a[164:167], v[100:115]
    ds_read_b128 a[172:175], v19 offset:32768
    buffer_load_dwordx4 v7, s[28:31], s88 offen offset:1024 lds
    s_waitcnt vmcnt(12) lgkmcnt(4)
    s_barrier
    v_mfma_f32_16x16x32_bf16 v[56:59], v[40:43], v[64:67], v[56:59]
    v_mfma_f32_4x4x4_16b_bf16 v[48:51], a[40:41], a[40:41], v[48:51]
    v_mfma_f32_4x4x4_16b_bf16 v[52:55], a[42:43], a[42:43], v[52:55]
    v_mfma_f32_16x16x32_bf16 v[44:47], v[40:43], a[40:43], v[44:47]
    ds_read_b64_tr_b16 v[60:61], v22 offset:24576
    ds_read_b64_tr_b16 v[62:63], v22 offset:25088
    v_mfma_f32_32x32x16_bf16 v[84:99], v[64:67], a[40:43], v[84:99]
    ds_read_b128 a[48:51], v12 offset:49152
    s_add_u32 m0, s7, 16384
    s_nop 0
    buffer_load_dwordx4 v2, s[24:27], s70 offen offset:0 lds
    v_mfma_f32_32x32x16_bf16 v[100:115], v[64:67], a[168:171], v[100:115]
    ds_read_b128 a[176:179], v16 offset:49152
    buffer_load_dwordx4 v3, s[24:27], s70 offen offset:1024 lds
    s_waitcnt lgkmcnt(4)
    v_mfma_f32_4x4x4_16b_bf16 v[48:51], a[44:45], a[44:45], v[48:51]
    v_mfma_f32_4x4x4_16b_bf16 v[52:55], a[46:47], a[46:47], v[52:55]
    v_mfma_f32_16x16x32_bf16 v[44:47], v[40:43], a[44:47], v[44:47]
    ds_read_b64_tr_b16 v[64:65], v23 offset:24576
    ds_read_b64_tr_b16 v[66:67], v23 offset:25088
    v_mfma_f32_32x32x16_bf16 v[84:99], v[68:71], a[44:47], v[84:99]
    ds_read_b128 a[52:55], v13 offset:49152
    buffer_load_dwordx4 v4, s[24:27], s70 offen offset:2048 lds
    v_mfma_f32_32x32x16_bf16 v[100:115], v[68:71], a[172:175], v[100:115]
    ds_read_b128 a[180:183], v17 offset:49152
    buffer_load_dwordx4 v5, s[24:27], s70 offen offset:3072 lds
    s_waitcnt lgkmcnt(4)
    v_mfma_f32_16x16x32_bf16 v[56:59], v[40:43], v[60:63], v[56:59]
    v_mfma_f32_4x4x4_16b_bf16 v[48:51], a[48:49], a[48:49], v[48:51]
    v_mfma_f32_4x4x4_16b_bf16 v[52:55], a[50:51], a[50:51], v[52:55]
    v_mfma_f32_16x16x32_bf16 v[44:47], v[40:43], a[48:51], v[44:47]
    ds_read_b64_tr_b16 v[68:69], v22 offset:28672
    ds_read_b64_tr_b16 v[70:71], v22 offset:29184
    v_mfma_f32_32x32x16_bf16 v[84:99], v[60:63], a[48:51], v[84:99]
    ds_read_b128 a[56:59], v14 offset:49152
    s_add_u32 m0, s8, 114688
    s_add_u32 s88, s78, s4
    buffer_load_dwordx4 v6, s[28:31], s88 offen lds
    v_mfma_f32_32x32x16_bf16 v[100:115], v[60:63], a[176:179], v[100:115]
    ds_read_b128 a[184:187], v18 offset:49152
    buffer_load_dwordx4 v7, s[28:31], s88 offen offset:1024 lds
    s_waitcnt lgkmcnt(4)
    v_mfma_f32_4x4x4_16b_bf16 v[48:51], a[52:53], a[52:53], v[48:51]
    v_mfma_f32_4x4x4_16b_bf16 v[52:55], a[54:55], a[54:55], v[52:55]
    v_mfma_f32_16x16x32_bf16 v[44:47], v[40:43], a[52:55], v[44:47]
    ds_read_b64_tr_b16 v[60:61], v23 offset:28672
    ds_read_b64_tr_b16 v[62:63], v23 offset:29184
    v_mfma_f32_32x32x16_bf16 v[84:99], v[64:67], a[52:55], v[84:99]
    ds_read_b128 a[60:63], v15 offset:49152
    v_mfma_f32_32x32x16_bf16 v[100:115], v[64:67], a[180:183], v[100:115]
    ds_read_b128 a[188:191], v19 offset:49152
    s_waitcnt vmcnt(12) lgkmcnt(4)
    s_barrier
    v_mfma_f32_16x16x32_bf16 v[56:59], v[40:43], v[68:71], v[56:59]
    v_mfma_f32_4x4x4_16b_bf16 v[48:51], a[56:57], a[56:57], v[48:51]
    v_mfma_f32_4x4x4_16b_bf16 v[52:55], a[58:59], a[58:59], v[52:55]
    v_mfma_f32_16x16x32_bf16 v[44:47], v[40:43], a[56:59], v[44:47]
    ds_read_b64_tr_b16 v[64:65], v22 offset:32768
    ds_read_b64_tr_b16 v[66:67], v22 offset:33280
    v_mfma_f32_32x32x16_bf16 v[84:99], v[68:71], a[56:59], v[84:99]
    v_add_u32 v37, 147456, v12
    ds_read_b128 a[64:67], v37
    s_add_u32 m0, s7, 32768
    s_nop 0
    buffer_load_dwordx4 v2, s[24:27], s71 offen offset:0 lds
    v_mfma_f32_32x32x16_bf16 v[100:115], v[68:71], a[184:187], v[100:115]
    v_add_u32 v37, 147456, v16
    ds_read_b128 a[192:195], v37
    buffer_load_dwordx4 v3, s[24:27], s71 offen offset:1024 lds
    s_waitcnt lgkmcnt(4)
    v_mfma_f32_4x4x4_16b_bf16 v[48:51], a[60:61], a[60:61], v[48:51]
    v_mfma_f32_4x4x4_16b_bf16 v[52:55], a[62:63], a[62:63], v[52:55]
    v_mfma_f32_16x16x32_bf16 v[44:47], v[40:43], a[60:63], v[44:47]
    ds_read_b64_tr_b16 v[68:69], v23 offset:32768
    ds_read_b64_tr_b16 v[70:71], v23 offset:33280
    v_mfma_f32_32x32x16_bf16 v[84:99], v[60:63], a[60:63], v[84:99]
    v_add_u32 v37, 147456, v13
    ds_read_b128 a[68:71], v37
    buffer_load_dwordx4 v4, s[24:27], s71 offen offset:2048 lds
    v_mfma_f32_32x32x16_bf16 v[100:115], v[60:63], a[188:191], v[100:115]
    v_add_u32 v37, 147456, v17
    ds_read_b128 a[196:199], v37
    buffer_load_dwordx4 v5, s[24:27], s71 offen offset:3072 lds
    s_waitcnt lgkmcnt(4)
    v_mfma_f32_16x16x32_bf16 v[56:59], v[40:43], v[64:67], v[56:59]
    v_mfma_f32_4x4x4_16b_bf16 v[48:51], a[64:65], a[64:65], v[48:51]
    v_mfma_f32_4x4x4_16b_bf16 v[52:55], a[66:67], a[66:67], v[52:55]
    v_mfma_f32_16x16x32_bf16 v[44:47], v[40:43], a[64:67], v[44:47]
    ds_read_b64_tr_b16 v[60:61], v22 offset:36864
    ds_read_b64_tr_b16 v[62:63], v22 offset:37376
    v_mfma_f32_32x32x16_bf16 v[84:99], v[64:67], a[64:67], v[84:99]
    v_add_u32 v37, 147456, v14
    ds_read_b128 a[72:75], v37
    s_add_u32 m0, s8, 122880
    s_add_u32 s88, s79, s4
    buffer_load_dwordx4 v6, s[28:31], s88 offen lds
    v_mfma_f32_32x32x16_bf16 v[100:115], v[64:67], a[192:195], v[100:115]
    v_add_u32 v37, 147456, v18
    ds_read_b128 a[200:203], v37
    buffer_load_dwordx4 v7, s[28:31], s88 offen offset:1024 lds
    s_waitcnt lgkmcnt(4)
    v_mfma_f32_4x4x4_16b_bf16 v[48:51], a[68:69], a[68:69], v[48:51]
    v_mfma_f32_4x4x4_16b_bf16 v[52:55], a[70:71], a[70:71], v[52:55]
    v_mfma_f32_16x16x32_bf16 v[44:47], v[40:43], a[68:71], v[44:47]
    ds_read_b64_tr_b16 v[64:65], v23 offset:36864
    ds_read_b64_tr_b16 v[66:67], v23 offset:37376
    v_mfma_f32_32x32x16_bf16 v[84:99], v[68:71], a[68:71], v[84:99]
    v_add_u32 v37, 147456, v15
    ds_read_b128 a[76:79], v37
    v_mfma_f32_32x32x16_bf16 v[100:115], v[68:71], a[196:199], v[100:115]
    v_add_u32 v37, 147456, v19
    ds_read_b128 a[204:207], v37
    s_waitcnt vmcnt(12) lgkmcnt(4)
    s_barrier
    v_mfma_f32_16x16x32_bf16 v[56:59], v[40:43], v[60:63], v[56:59]
    v_mfma_f32_4x4x4_16b_bf16 v[48:51], a[72:73], a[72:73], v[48:51]
    v_mfma_f32_4x4x4_16b_bf16 v[52:55], a[74:75], a[74:75], v[52:55]
    v_mfma_f32_16x16x32_bf16 v[44:47], v[40:43], a[72:75], v[44:47]
    ds_read_b64_tr_b16 v[68:69], v22 offset:40960
    ds_read_b64_tr_b16 v[70:71], v22 offset:41472
    v_mfma_f32_32x32x16_bf16 v[84:99], v[60:63], a[72:75], v[84:99]
    ds_read_b128 a[80:83], v12 offset:0
    s_add_u32 m0, s8, 65536
    s_add_u32 s88, s80, s5
    buffer_load_dwordx4 v8, s[32:35], s88 offen lds
    v_mfma_f32_32x32x16_bf16 v[100:115], v[60:63], a[200:203], v[100:115]
    ds_read_b128 a[208:211], v16 offset:0
    buffer_load_dwordx4 v9, s[32:35], s88 offen offset:1024 lds
    s_waitcnt lgkmcnt(4)
    v_mfma_f32_4x4x4_16b_bf16 v[48:51], a[76:77], a[76:77], v[48:51]
    v_mfma_f32_4x4x4_16b_bf16 v[52:55], a[78:79], a[78:79], v[52:55]
    v_mfma_f32_16x16x32_bf16 v[44:47], v[40:43], a[76:79], v[44:47]
    ds_read_b64_tr_b16 v[60:61], v23 offset:40960
    ds_read_b64_tr_b16 v[62:63], v23 offset:41472
    v_mfma_f32_32x32x16_bf16 v[84:99], v[64:67], a[76:79], v[84:99]
    ds_read_b128 a[84:87], v13 offset:0
    s_add_u32 m0, s8, 73728
    s_add_u32 s88, s81, s5
    buffer_load_dwordx4 v8, s[32:35], s88 offen lds
    v_mfma_f32_32x32x16_bf16 v[100:115], v[64:67], a[204:207], v[100:115]
    ds_read_b128 a[212:215], v17 offset:0
    buffer_load_dwordx4 v9, s[32:35], s88 offen offset:1024 lds
    s_waitcnt lgkmcnt(4)
    v_mfma_f32_16x16x32_bf16 v[56:59], v[40:43], v[68:71], v[56:59]
    v_mfma_f32_4x4x4_16b_bf16 v[48:51], a[80:81], a[80:81], v[48:51]
    v_mfma_f32_4x4x4_16b_bf16 v[52:55], a[82:83], a[82:83], v[52:55]
    v_mfma_f32_16x16x32_bf16 v[44:47], v[40:43], a[80:83], v[44:47]
    ds_read_b64_tr_b16 v[64:65], v22 offset:45056
    ds_read_b64_tr_b16 v[66:67], v22 offset:45568
    v_mfma_f32_32x32x16_bf16 v[84:99], v[68:71], a[80:83], v[84:99]
    ds_read_b128 a[88:91], v14 offset:0
    s_add_u32 m0, s8, 81920
    s_add_u32 s88, s72, s6
    v_or_b32 v6, v6, v31
    v_or_b32 v7, v7, v31
    buffer_load_dwordx4 v6, s[28:31], s88 offen lds
    v_mfma_f32_32x32x16_bf16 v[100:115], v[68:71], a[208:211], v[100:115]
    ds_read_b128 a[216:219], v18 offset:0
    buffer_load_dwordx4 v7, s[28:31], s88 offen offset:1024 lds
    s_waitcnt lgkmcnt(4)
    v_mfma_f32_4x4x4_16b_bf16 v[48:51], a[84:85], a[84:85], v[48:51]
    v_mfma_f32_4x4x4_16b_bf16 v[52:55], a[86:87], a[86:87], v[52:55]
    v_mfma_f32_16x16x32_bf16 v[44:47], v[40:43], a[84:87], v[44:47]
    ds_read_b64_tr_b16 v[68:69], v23 offset:45056
    ds_read_b64_tr_b16 v[70:71], v23 offset:45568
    v_mfma_f32_32x32x16_bf16 v[84:99], v[60:63], a[84:87], v[84:99]
    ds_read_b128 a[92:95], v15 offset:0
    v_mfma_f32_32x32x16_bf16 v[100:115], v[60:63], a[212:215], v[100:115]
    ds_read_b128 a[220:223], v19 offset:0
    s_waitcnt vmcnt(12) lgkmcnt(4)
    s_barrier
    buffer_load_dword v245, v39, s[40:43], 0 offen sc1
    v_mfma_f32_16x16x32_bf16 v[56:59], v[40:43], v[64:67], v[56:59]
    v_mfma_f32_4x4x4_16b_bf16 v[48:51], a[88:89], a[88:89], v[48:51]
    v_mfma_f32_4x4x4_16b_bf16 v[52:55], a[90:91], a[90:91], v[52:55]
    v_mfma_f32_16x16x32_bf16 v[44:47], v[40:43], a[88:91], v[44:47]
    ds_read_b64_tr_b16 v[60:61], v22 offset:49152
    ds_read_b64_tr_b16 v[62:63], v22 offset:49664
    v_mfma_f32_32x32x16_bf16 v[84:99], v[64:67], a[88:91], v[84:99]
    ds_read_b128 a[96:99], v12 offset:16384
    s_add_u32 m0, s8, 49152
    s_add_u32 s88, s73, s6
    buffer_load_dwordx4 v6, s[28:31], s88 offen lds
    v_mfma_f32_32x32x16_bf16 v[100:115], v[64:67], a[216:219], v[100:115]
    ds_read_b128 a[224:227], v16 offset:16384
    buffer_load_dwordx4 v7, s[28:31], s88 offen offset:1024 lds
    s_waitcnt lgkmcnt(4)
    v_mfma_f32_4x4x4_16b_bf16 v[48:51], a[92:93], a[92:93], v[48:51]
    v_mfma_f32_4x4x4_16b_bf16 v[52:55], a[94:95], a[94:95], v[52:55]
    v_mfma_f32_16x16x32_bf16 v[44:47], v[40:43], a[92:95], v[44:47]
    ds_read_b64_tr_b16 v[64:65], v23 offset:49152
    ds_read_b64_tr_b16 v[66:67], v23 offset:49664
    v_mfma_f32_32x32x16_bf16 v[84:99], v[68:71], a[92:95], v[84:99]
    ds_read_b128 a[100:103], v13 offset:16384
    v_mfma_f32_32x32x16_bf16 v[100:115], v[68:71], a[220:223], v[100:115]
    ds_read_b128 a[228:231], v17 offset:16384
    s_waitcnt lgkmcnt(4)
    v_mfma_f32_16x16x32_bf16 v[56:59], v[40:43], v[60:63], v[56:59]
    v_mfma_f32_4x4x4_16b_bf16 v[48:51], a[96:97], a[96:97], v[48:51]
    v_mfma_f32_4x4x4_16b_bf16 v[52:55], a[98:99], a[98:99], v[52:55]
    v_mfma_f32_16x16x32_bf16 v[44:47], v[40:43], a[96:99], v[44:47]
    ds_read_b64_tr_b16 v[68:69], v22 offset:53248
    ds_read_b64_tr_b16 v[70:71], v22 offset:53760
    v_mfma_f32_32x32x16_bf16 v[84:99], v[60:63], a[96:99], v[84:99]
    ds_read_b128 a[104:107], v14 offset:16384
    v_mfma_f32_32x32x16_bf16 v[100:115], v[60:63], a[224:227], v[100:115]
    ds_read_b128 a[232:235], v18 offset:16384
    s_waitcnt lgkmcnt(4)
    v_mfma_f32_4x4x4_16b_bf16 v[48:51], a[100:101], a[100:101], v[48:51]
    v_mfma_f32_4x4x4_16b_bf16 v[52:55], a[102:103], a[102:103], v[52:55]
    v_mfma_f32_16x16x32_bf16 v[44:47], v[40:43], a[100:103], v[44:47]
    ds_read_b64_tr_b16 v[60:61], v23 offset:53248
    ds_read_b64_tr_b16 v[62:63], v23 offset:53760
    v_mfma_f32_32x32x16_bf16 v[84:99], v[64:67], a[100:103], v[84:99]
    ds_read_b128 a[108:111], v15 offset:16384
    v_mfma_f32_32x32x16_bf16 v[100:115], v[64:67], a[228:231], v[100:115]
    ds_read_b128 a[236:239], v19 offset:16384
    s_waitcnt vmcnt(9) lgkmcnt(4)
    s_barrier
    s_and_b32 s65, s62, 3
    s_lshl_b32 s65, s65, 1
    s_add_u32 s65, s65, s63
    s_and_b32 s65, s65, 7
    s_lshl_b32 s12, s65, 14
    s_lshl_b32 s64, s65, 10
    s_or_b32 s101, s101, s64
    s_or_b32 s64, s64, s99
    v_mfma_f32_16x16x32_bf16 v[56:59], v[40:43], v[68:71], v[56:59]
    v_mfma_f32_4x4x4_16b_bf16 v[48:51], a[104:105], a[104:105], v[48:51]
    v_mfma_f32_4x4x4_16b_bf16 v[52:55], a[106:107], a[106:107], v[52:55]
    v_mfma_f32_16x16x32_bf16 v[44:47], v[40:43], a[104:107], v[44:47]
    ds_read_b64_tr_b16 v[64:65], v22 offset:57344
    ds_read_b64_tr_b16 v[66:67], v22 offset:57856
    v_mfma_f32_32x32x16_bf16 v[84:99], v[68:71], a[104:107], v[84:99]
    ds_read_b128 a[112:115], v12 offset:32768
    v_mfma_f32_32x32x16_bf16 v[100:115], v[68:71], a[232:235], v[100:115]
    ds_read_b128 a[240:243], v16 offset:32768
    s_waitcnt lgkmcnt(4)
    v_mfma_f32_4x4x4_16b_bf16 v[48:51], a[108:109], a[108:109], v[48:51]
    v_mfma_f32_4x4x4_16b_bf16 v[52:55], a[110:111], a[110:111], v[52:55]
    v_mfma_f32_16x16x32_bf16 v[44:47], v[40:43], a[108:111], v[44:47]
    ds_read_b64_tr_b16 v[68:69], v23 offset:57344
    ds_read_b64_tr_b16 v[70:71], v23 offset:57856
    v_mfma_f32_32x32x16_bf16 v[84:99], v[60:63], a[108:111], v[84:99]
    ds_read_b128 a[116:119], v13 offset:32768
    v_mfma_f32_32x32x16_bf16 v[100:115], v[60:63], a[236:239], v[100:115]
    ds_read_b128 a[244:247], v17 offset:32768
    v_cndmask_b32 v37, v56, v57, s[16:17]
    ds_write_b32 v26, v37
    s_waitcnt lgkmcnt(5)
    v_mfma_f32_16x16x32_bf16 v[56:59], v[40:43], v[64:67], v[56:59]
    v_mfma_f32_4x4x4_16b_bf16 v[48:51], a[112:113], a[112:113], v[48:51]
    v_mfma_f32_4x4x4_16b_bf16 v[52:55], a[114:115], a[114:115], v[52:55]
    v_mfma_f32_16x16x32_bf16 v[44:47], v[40:43], a[112:115], v[44:47]
    ds_read_b64_tr_b16 v[60:61], v22 offset:61440
    ds_read_b64_tr_b16 v[62:63], v22 offset:61952
    v_mfma_f32_32x32x16_bf16 v[84:99], v[64:67], a[112:115], v[84:99]
    ds_read_b128 a[120:123], v14 offset:32768
    v_mfma_f32_32x32x16_bf16 v[100:115], v[64:67], a[240:243], v[100:115]
    ds_read_b128 a[248:251], v18 offset:32768
    s_waitcnt lgkmcnt(5)
    v_mfma_f32_16x16x32_bf16 v[56:59], v[40:43], v[68:71], v[56:59]
    v_mfma_f32_4x4x4_16b_bf16 v[48:51], a[116:117], a[116:117], v[48:51]
    v_mfma_f32_4x4x4_16b_bf16 v[52:55], a[118:119], a[118:119], v[52:55]
    v_mfma_f32_16x16x32_bf16 v[44:47], v[40:43], a[116:119], v[44:47]
    ds_read_b64_tr_b16 v[64:65], v23 offset:61440
    ds_read_b64_tr_b16 v[66:67], v23 offset:61952
    v_mfma_f32_32x32x16_bf16 v[84:99], v[68:71], a[116:119], v[84:99]
    ds_read_b128 a[124:127], v15 offset:32768
    v_mfma_f32_32x32x16_bf16 v[100:115], v[68:71], a[244:247], v[100:115]
    ds_read_b128 a[252:255], v19 offset:32768
    s_waitcnt vmcnt(7) lgkmcnt(4)
    s_barrier
    v_mfma_f32_16x16x32_bf16 v[56:59], v[40:43], v[60:63], v[56:59]
    v_mfma_f32_4x4x4_16b_bf16 v[48:51], a[120:121], a[120:121], v[48:51]
    v_mfma_f32_4x4x4_16b_bf16 v[52:55], a[122:123], a[122:123], v[52:55]
    v_mfma_f32_16x16x32_bf16 v[44:47], v[40:43], a[120:123], v[44:47]
    ds_read_b64_tr_b16 v[68:69], v22 offset:0
    ds_read_b64_tr_b16 v[70:71], v22 offset:512
    v_mfma_f32_32x32x16_bf16 v[84:99], v[60:63], a[120:123], v[84:99]
    s_add_u32 m0, s8, 57344
    s_add_u32 s88, s82, s5
    buffer_load_dwordx4 v8, s[32:35], s88 offen lds
    v_mfma_f32_32x32x16_bf16 v[100:115], v[60:63], a[248:251], v[100:115]
    ds_read_b32 v36, v27
    buffer_load_dwordx4 v9, s[32:35], s88 offen offset:1024 lds
    s_waitcnt lgkmcnt(3)
    v_mfma_f32_16x16x32_bf16 v[56:59], v[40:43], v[64:67], v[56:59]
    v_mfma_f32_4x4x4_16b_bf16 v[48:51], a[124:125], a[124:125], v[48:51]
    v_mfma_f32_4x4x4_16b_bf16 v[52:55], a[126:127], a[126:127], v[52:55]
    v_mfma_f32_16x16x32_bf16 v[44:47], v[40:43], a[124:127], v[44:47]
    ds_read_b64_tr_b16 v[60:61], v23 offset:0
    ds_read_b64_tr_b16 v[62:63], v23 offset:512
    v_mfma_f32_32x32x16_bf16 v[84:99], v[64:67], a[124:127], v[84:99]
    s_add_u32 m0, s8, 90112
    s_add_u32 s88, s83, s5
    buffer_load_dwordx4 v8, s[32:35], s88 offen lds
    v_mfma_f32_32x32x16_bf16 v[100:115], v[64:67], a[252:255], v[100:115]
    buffer_load_dwordx4 v9, s[32:35], s88 offen offset:1024 lds
    s_waitcnt lgkmcnt(3)
    s_waitcnt lgkmcnt(2)
    v_cndmask_b32 v38, v56, v57, s[16:17]
    v_mfma_f32_16x16x32_bf16 v[56:59], v[40:43], v[68:71], 0
    v_mfma_f32_32x32x16_bf16 v[116:131], v[68:71], a[0:3], 0
    ds_read_b64_tr_b16 v[64:65], v22 offset:4096
    ds_read_b64_tr_b16 v[66:67], v22 offset:4608
    s_add_u32 m0, s8, 98304
    s_add_u32 s88, s84, s5
    buffer_load_dwordx4 v8, s[32:35], s88 offen lds
    v_mfma_f32_32x32x16_bf16 v[132:147], v[68:71], a[128:131], 0
    buffer_load_dwordx4 v9, s[32:35], s88 offen offset:1024 lds
    s_waitcnt lgkmcnt(2)
    v_cndmask_b32 v213, v44, v45, s[16:17]
    v_add_f32 v48, v48, v52
    v_add_f32 v49, v49, v53
    v_mfma_f32_32x32x16_bf16 v[116:131], v[60:63], a[4:7], v[116:131]
    ds_read_b64_tr_b16 v[68:69], v23 offset:4096
    ds_read_b64_tr_b16 v[70:71], v23 offset:4608
    v_add_f32 v50, v50, v54
    v_add_f32 v51, v51, v55
    v_cndmask_b32 v214, v48, v49, s[20:21]
    v_cndmask_b32 v215, v50, v51, s[20:21]
    v_mfma_f32_32x32x16_bf16 v[132:147], v[60:63], a[132:135], v[132:147]
    s_waitcnt vmcnt(11) lgkmcnt(2)
    s_barrier
    v_cndmask_b32 v214, v214, v215, s[22:23]
    v_mov_b32 v215, v214
    v_mul_f32 v213, 0x3b000000, v213
    v_cvt_pk_bf16_f32 v72, v213, v213
    v_mfma_f32_16x16x32_bf16 v[56:59], v[40:43], v[64:67], v[56:59]
    v_mfma_f32_32x32x16_bf16 v[116:131], v[64:67], a[8:11], v[116:131]
    ds_read_b64_tr_b16 v[60:61], v22 offset:8192
    ds_read_b64_tr_b16 v[62:63], v22 offset:8704
    s_lshl_b32 s9, s62, 3
    s_add_u32 s9, s9, s63
    s_mul_i32 s9, s9, 5504
    s_cmp_eq_u32 s59, 0
    s_cselect_b32 s9, s9, 1073741824
    v_lshlrev_b32 v252, 7, v1
    s_mov_b32 exec_lo, 0xffffffff
    s_mov_b32 exec_hi, 0x7ff
    buffer_load_dword v253, v252, s[44:47], s9 offen
    s_mov_b64 exec, -1
    v_mfma_f32_32x32x16_bf16 v[132:147], v[64:67], a[136:139], v[132:147]
    s_waitcnt lgkmcnt(2)
    v_permlane32_swap_b32 v214, v215
    v_add_f32 v214, v214, v215
    v_mul_f32 v214, 0x3b000000, v214
    v_fma_f32 v214, -v213, v213, v214
    v_mfma_f32_32x32x16_bf16 v[116:131], v[68:71], a[12:15], v[116:131]
    ds_read_b64_tr_b16 v[64:65], v23 offset:8192
    ds_read_b64_tr_b16 v[66:67], v23 offset:8704
    s_lshl_b32 s9, s62, 3
    s_add_u32 s9, s9, s63
    s_mul_i32 s9, s9, 2048
    s_cmp_eq_u32 s59, 1
    s_cselect_b32 s9, s9, 1073741824
    v_lshlrev_b32 v252, 7, v1
    s_mov_b32 exec_lo, 0xffff
    s_mov_b32 exec_hi, 0x0
    buffer_load_dword v253, v252, s[48:51], s9 offen
    s_mov_b64 exec, -1
    v_mfma_f32_32x32x16_bf16 v[132:147], v[68:71], a[140:143], v[132:147]
    s_waitcnt lgkmcnt(2)
    v_max_f32 v214, 0, v214
    v_cvt_pk_bf16_f32 v214, v214, v214
    v_and_b32 v214, 0xffff0000, v214
    v_add_f32 v214, 0x3727c5ac, v214
    v_mfma_f32_16x16x32_bf16 v[56:59], v[40:43], v[60:63], v[56:59]
    v_mfma_f32_32x32x16_bf16 v[116:131], v[60:63], a[16:19], v[116:131]
    ds_read_b64_tr_b16 v[68:69], v22 offset:12288
    ds_read_b64_tr_b16 v[70:71], v22 offset:12800
    s_and_b32 s9, s62, 3
    s_lshl_b32 s9, s9, 3
    s_add_u32 s9, s9, s63
    s_mul_i32 s9, s9, 44032
    s_cmp_eq_u32 s59, 2
    s_cselect_b32 s9, s9, 1073741824
    v_lshlrev_b32 v252, 10, v1
    s_mov_b32 exec_lo, 0xffffffff
    s_mov_b32 exec_hi, 0x7ff
    buffer_load_dword v253, v252, s[44:47], s9 offen offset:384
    s_mov_b64 exec, -1
    v_mfma_f32_32x32x16_bf16 v[132:147], v[60:63], a[144:147], v[132:147]
    s_waitcnt lgkmcnt(2)
    v_cvt_pk_bf16_f32 v214, v214, v214
    v_and_b32 v214, 0xffff0000, v214
    v_sqrt_f32 v214, v214
    v_mfma_f32_32x32x16_bf16 v[116:131], v[64:67], a[20:23], v[116:131]
    ds_read_b64_tr_b16 v[60:61], v23 offset:12288
    ds_read_b64_tr_b16 v[62:63], v23 offset:12800
    s_and_b32 s9, s62, 3
    s_lshl_b32 s9, s9, 3
    s_add_u32 s9, s9, s63
    s_mul_i32 s9, s9, 16384
    s_cmp_eq_u32 s59, 3
    s_cselect_b32 s9, s9, 1073741824
    v_lshlrev_b32 v252, 10, v1
    s_mov_b32 exec_lo, 0xffff
    s_mov_b32 exec_hi, 0x0
    buffer_load_dword v253, v252, s[48:51], s9 offen offset:384
    s_mov_b64 exec, -1
    v_mfma_f32_32x32x16_bf16 v[132:147], v[64:67], a[148:151], v[132:147]
    s_waitcnt vmcnt(8) lgkmcnt(2)
    s_barrier
    s_mov_b32 s90, 0
    v_readlane_b32 s92, v245, 16
    v_readlane_b32 s93, v245, 17
    s_nop 0
    s_cmp_lg_u32 s92, 0
    s_cbranch_scc1 L_POK5
L_PL5:
    s_sleep 2
    buffer_load_dword v245, v39, s[40:43], 0 offen sc1
    s_waitcnt vmcnt(0)
    s_add_u32 s90, s90, 1
    s_cmp_gt_u32 s90, 200000
    s_cbranch_scc1 L_POK5
    v_readlane_b32 s92, v245, 16
    v_readlane_b32 s93, v245, 17
    s_nop 0
    s_cmp_lg_u32 s92, 0
    s_cbranch_scc0 L_PL5
L_POK5:
    s_nop 4
    v_mov_b32 v250, s92
    v_mov_b32 v251, s93
    ds_write_b32 v29, v72
    v_cvt_pk_bf16_f32 v214, v214, v214
    v_and_b32 v214, 0xffff0000, v214
    v_mfma_f32_16x16x32_bf16 v[56:59], v[40:43], v[68:71], v[56:59]
    v_mfma_f32_32x32x16_bf16 v[116:131], v[68:71], a[24:27], v[116:131]
    ds_read_b64_tr_b16 v[64:65], v20 offset:57344
    ds_read_b64_tr_b16 v[66:67], v20 offset:57856
    s_add_u32 m0, s8, 147456
    s_add_u32 s88, s85, s5
    buffer_load_dwordx4 v8, s[32:35], s88 offen lds
    v_mfma_f32_32x32x16_bf16 v[132:147], v[68:71], a[152:155], v[132:147]
    buffer_load_dwordx4 v9, s[32:35], s88 offen offset:1024 lds
    s_waitcnt lgkmcnt(3)
    v_rcp_f32 v34, v214
    v_add_f32 v38, v38, v36
    v_mfma_f32_32x32x16_bf16 v[116:131], v[60:63], a[28:31], v[116:131]
    ds_read_b64_tr_b16 v[68:69], v21 offset:57344
    ds_read_b64_tr_b16 v[70:71], v21 offset:57856
    ds_write_b32 v29, v34 offset:512
    v_cvt_pk_bf16_f32 v212, -v38, -v38
    v_and_b32 v212, 0xffff0000, v212
    v_sub_f32 v212, -v38, v212
    v_mfma_f32_32x32x16_bf16 v[132:147], v[60:63], a[156:159], v[132:147]
    s_add_u32 m0, s8, 155648
    s_add_u32 s88, s86, s5
    buffer_load_dwordx4 v8, s[32:35], s88 offen lds
    s_waitcnt lgkmcnt(3)
    v_cvt_pk_bf16_f32 v212, -v38, v212
    v_mfma_f32_16x16x32_bf16 v[56:59], v[40:43], v[64:67], v[56:59]
    v_mfma_f32_32x32x16_bf16 v[116:131], v[64:67], a[32:35], v[116:131]
    ds_read_b64_tr_b16 v[60:61], v20 offset:61440
    ds_read_b64_tr_b16 v[62:63], v20 offset:61952
    buffer_load_dwordx4 v9, s[32:35], s88 offen offset:1024 lds
    v_cndmask_b32 v80, v212, 0, s[18:19]
    v_mfma_f32_32x32x16_bf16 v[132:147], v[64:67], a[160:163], v[132:147]
    s_waitcnt lgkmcnt(3)
    v_mfma_f32_32x32x16_bf16 v[116:131], v[68:71], a[36:39], v[116:131]
    ds_read_b64_tr_b16 v[64:65], v21 offset:61440
    ds_read_b64_tr_b16 v[66:67], v21 offset:61952
    v_mfma_f32_32x32x16_bf16 v[132:147], v[68:71], a[164:167], v[132:147]
    s_add_u32 m0, s8, 0
    s_add_u32 s88, s87, s5
    buffer_load_dwordx4 v8, s[32:35], s88 offen lds
    s_waitcnt vmcnt(11) lgkmcnt(2)
    s_barrier
    v_mfma_f32_16x16x32_bf16 v[56:59], v[40:43], v[60:63], v[56:59]
    v_mfma_f32_32x32x16_bf16 v[116:131], v[60:63], a[40:43], v[116:131]
    ds_read_b64_tr_b16 v[68:69], v22 offset:24576
    ds_read_b64_tr_b16 v[70:71], v22 offset:25088
    buffer_load_dwordx4 v9, s[32:35], s88 offen offset:1024 lds
    ds_read_b32 v76, v30
    ds_read_b32 v35, v30 offset:512
    v_mfma_f32_32x32x16_bf16 v[132:147], v[60:63], a[168:171], v[132:147]
    s_waitcnt lgkmcnt(4)
    v_mfma_f32_32x32x16_bf16 v[116:131], v[64:67], a[44:47], v[116:131]
    ds_read_b64_tr_b16 v[60:61], v23 offset:24576
    ds_read_b64_tr_b16 v[62:63], v23 offset:25088
    s_waitcnt lgkmcnt(2)
    v_mfma_f32_32x32x16_bf16 v[132:147], v[64:67], a[172:175], v[132:147]
    s_add_u32 m0, s8, 8192
    s_add_u32 s88, s74, s6
    buffer_load_dwordx4 v6, s[28:31], s88 offen lds
    v_mfma_f32_32x32x16_bf16 v[84:99], v[80:83], v[72:75], v[84:99]
    buffer_load_dwordx4 v7, s[28:31], s88 offen offset:1024 lds
    v_mfma_f32_32x32x16_bf16 v[100:115], v[80:83], v[76:79], v[100:115]
    v_mfma_f32_16x16x32_bf16 v[56:59], v[40:43], v[68:71], v[56:59]
    v_mfma_f32_32x32x16_bf16 v[116:131], v[68:71], a[48:51], v[116:131]
    ds_read_b64_tr_b16 v[64:65], v22 offset:28672
    ds_read_b64_tr_b16 v[66:67], v22 offset:29184
    v_mfma_f32_32x32x16_bf16 v[132:147], v[68:71], a[176:179], v[132:147]
    s_waitcnt lgkmcnt(2)
    s_nop 3
    v_pk_mul_f32 v[84:85], v[84:85], v[34:35] op_sel:[0,0] op_sel_hi:[1,0]
    v_pk_mul_f32 v[86:87], v[86:87], v[34:35] op_sel:[0,0] op_sel_hi:[1,0]
    v_pk_mul_f32 v[88:89], v[88:89], v[34:35] op_sel:[0,0] op_sel_hi:[1,0]
    v_pk_mul_f32 v[90:91], v[90:91], v[34:35] op_sel:[0,0] op_sel_hi:[1,0]
    v_pk_mul_f32 v[92:93], v[92:93], v[34:35] op_sel:[0,0] op_sel_hi:[1,0]
    v_pk_mul_f32 v[94:95], v[94:95], v[34:35] op_sel:[0,0] op_sel_hi:[1,0]
    v_pk_mul_f32 v[96:97], v[96:97], v[34:35] op_sel:[0,0] op_sel_hi:[1,0]
    v_pk_mul_f32 v[98:99], v[98:99], v[34:35] op_sel:[0,0] op_sel_hi:[1,0]
    v_pk_mul_f32 v[100:101], v[100:101], v[34:35] op_sel:[0,1] op_sel_hi:[1,1]
    v_pk_mul_f32 v[102:103], v[102:103], v[34:35] op_sel:[0,1] op_sel_hi:[1,1]
    v_pk_mul_f32 v[104:105], v[104:105], v[34:35] op_sel:[0,1] op_sel_hi:[1,1]
    v_pk_mul_f32 v[106:107], v[106:107], v[34:35] op_sel:[0,1] op_sel_hi:[1,1]
    v_pk_mul_f32 v[108:109], v[108:109], v[34:35] op_sel:[0,1] op_sel_hi:[1,1]
    v_pk_mul_f32 v[110:111], v[110:111], v[34:35] op_sel:[0,1] op_sel_hi:[1,1]
    v_pk_mul_f32 v[112:113], v[112:113], v[34:35] op_sel:[0,1] op_sel_hi:[1,1]
    v_pk_mul_f32 v[114:115], v[114:115], v[34:35] op_sel:[0,1] op_sel_hi:[1,1]
    s_add_u32 m0, s8, 106496
    s_add_u32 s88, s75, s6
    buffer_load_dwordx4 v6, s[28:31], s88 offen lds
    v_mfma_f32_32x32x16_bf16 v[116:131], v[60:63], a[52:55], v[116:131]
    ds_read_b64_tr_b16 v[68:69], v23 offset:28672
    ds_read_b64_tr_b16 v[70:71], v23 offset:29184
    buffer_load_dwordx4 v7, s[28:31], s88 offen offset:1024 lds
    v_cvt_pk_bf16_f32 v196, v84, v85
    v_cvt_pk_bf16_f32 v197, v86, v87
    v_mfma_f32_32x32x16_bf16 v[132:147], v[60:63], a[180:183], v[132:147]
    s_waitcnt vmcnt(14) lgkmcnt(2)
    s_barrier
    v_cvt_pk_bf16_f32 v198, v88, v89
    v_cvt_pk_bf16_f32 v199, v90, v91
    v_pk_max_i16 v196, v196, 0
    v_pk_max_i16 v197, v197, 0
    v_mfma_f32_16x16x32_bf16 v[56:59], v[40:43], v[64:67], v[56:59]
    v_mfma_f32_32x32x16_bf16 v[116:131], v[64:67], a[56:59], v[116:131]
    ds_read_b64_tr_b16 v[60:61], v22 offset:32768
    ds_read_b64_tr_b16 v[62:63], v22 offset:33280
    v_pk_max_i16 v198, v198, 0
    v_pk_max_i16 v199, v199, 0
    v_cvt_pk_bf16_f32 v200, v92, v93
    v_cvt_pk_bf16_f32 v201, v94, v95
    v_mfma_f32_32x32x16_bf16 v[132:147], v[64:67], a[184:187], v[132:147]
    s_waitcnt lgkmcnt(2)
    v_cvt_pk_bf16_f32 v202, v96, v97
    v_cvt_pk_bf16_f32 v203, v98, v99
    v_pk_max_i16 v200, v200, 0
    v_pk_max_i16 v201, v201, 0
    v_mfma_f32_32x32x16_bf16 v[116:131], v[68:71], a[60:63], v[116:131]
    ds_read_b64_tr_b16 v[64:65], v23 offset:32768
    ds_read_b64_tr_b16 v[66:67], v23 offset:33280
    s_add_u32 m0, s8, 16384
    s_add_u32 s88, s76, s6
    buffer_load_dwordx4 v6, s[28:31], s88 offen lds
    v_mfma_f32_32x32x16_bf16 v[132:147], v[68:71], a[188:191], v[132:147]
    buffer_load_dwordx4 v7, s[28:31], s88 offen offset:1024 lds
    s_waitcnt lgkmcnt(2)
    v_pk_max_i16 v202, v202, 0
    v_pk_max_i16 v203, v203, 0
    v_cvt_pk_bf16_f32 v204, v100, v101
    v_mfma_f32_16x16x32_bf16 v[56:59], v[40:43], v[60:63], v[56:59]
    v_mfma_f32_32x32x16_bf16 v[116:131], v[60:63], a[64:67], v[116:131]
    ds_read_b64_tr_b16 v[68:69], v22 offset:36864
    ds_read_b64_tr_b16 v[70:71], v22 offset:37376
    s_mul_i32 s9, s10, 131072
    s_add_u32 s9, s9, s94
    buffer_store_dwordx4 v[196:199], v28, s[36:39], s9 offen sc1
    v_mfma_f32_32x32x16_bf16 v[132:147], v[60:63], a[192:195], v[132:147]
    buffer_store_dwordx4 v[200:203], v28, s[36:39], s9 offen offset:1024 sc1
    s_waitcnt lgkmcnt(2)
    v_cvt_pk_bf16_f32 v205, v102, v103
    v_cvt_pk_bf16_f32 v206, v104, v105
    v_cvt_pk_bf16_f32 v207, v106, v107
    v_mfma_f32_32x32x16_bf16 v[116:131], v[64:67], a[68:71], v[116:131]
    ds_read_b64_tr_b16 v[60:61], v23 offset:36864
    ds_read_b64_tr_b16 v[62:63], v23 offset:37376
    v_pk_max_i16 v204, v204, 0
    v_pk_max_i16 v205, v205, 0
    v_pk_max_i16 v206, v206, 0
    v_pk_max_i16 v207, v207, 0
    v_mfma_f32_32x32x16_bf16 v[132:147], v[64:67], a[196:199], v[132:147]
    s_waitcnt vmcnt(12) lgkmcnt(2)
    s_barrier
    v_cvt_pk_bf16_f32 v208, v108, v109
    v_cvt_pk_bf16_f32 v209, v110, v111
    v_cvt_pk_bf16_f32 v210, v112, v113
    v_cvt_pk_bf16_f32 v211, v114, v115
    v_mfma_f32_16x16x32_bf16 v[56:59], v[40:43], v[68:71], v[56:59]
    v_mfma_f32_32x32x16_bf16 v[116:131], v[68:71], a[72:75], v[116:131]
    ds_read_b64_tr_b16 v[64:65], v24 offset:16384
    ds_read_b64_tr_b16 v[66:67], v24 offset:16896
    v_pk_max_i16 v208, v208, 0
    v_pk_max_i16 v209, v209, 0
    v_pk_max_i16 v210, v210, 0
    v_pk_max_i16 v211, v211, 0
    v_mfma_f32_32x32x16_bf16 v[132:147], v[68:71], a[200:203], v[132:147]
    s_add_u32 m0, s8, 24576
    s_add_u32 s88, s77, s6
    buffer_load_dwordx4 v6, s[28:31], s88 offen lds
    s_waitcnt lgkmcnt(2)
    v_mul_f32 v52, s14, v34
    v_mfma_f32_32x32x16_bf16 v[116:131], v[60:63], a[76:79], v[116:131]
    ds_read_b64_tr_b16 v[68:69], v25 offset:16384
    ds_read_b64_tr_b16 v[70:71], v25 offset:16896
    buffer_load_dwordx4 v7, s[28:31], s88 offen offset:1024 lds
    v_mul_f32 v53, s14, v35
    v_mfma_f32_32x32x16_bf16 v[132:147], v[60:63], a[204:207], v[132:147]
    s_mul_i32 s9, s11, 131072
    s_add_u32 s9, s9, s94
    buffer_store_dwordx4 v[204:207], v28, s[36:39], s9 offen sc1
    s_waitcnt lgkmcnt(2)
    v_mfma_f32_16x16x32_bf16 v[56:59], v[40:43], v[64:67], v[56:59]
    v_mfma_f32_32x32x16_bf16 v[116:131], v[64:67], a[80:83], v[116:131]
    ds_read_b64_tr_b16 v[60:61], v24 offset:20480
    ds_read_b64_tr_b16 v[62:63], v24 offset:20992
    buffer_store_dwordx4 v[208:211], v28, s[36:39], s9 offen offset:1024 sc1
    v_rcp_f32 v54, v34
    v_mfma_f32_32x32x16_bf16 v[132:147], v[64:67], a[208:211], v[132:147]
    s_waitcnt lgkmcnt(2)
    v_rcp_f32 v55, v35
    v_add_u32 v12, s8, v247
    v_xor_b32 v13, 64, v12
    v_mfma_f32_32x32x16_bf16 v[116:131], v[68:71], a[84:87], v[116:131]
    ds_read_b64_tr_b16 v[64:65], v25 offset:20480
    ds_read_b64_tr_b16 v[66:67], v25 offset:20992
    v_add_u32 v14, 65536, v12
    v_add_u32 v15, 65536, v13
    v_add_u32 v16, 131072, v12
    v_add_u32 v17, 131072, v13
    v_mfma_f32_32x32x16_bf16 v[132:147], v[68:71], a[212:215], v[132:147]
    s_waitcnt vmcnt(14) lgkmcnt(2)
    s_barrier
    v_lshrrev_b32 v2, 5, v1
    v_lshlrev_b32 v3, 8, v2
    v_lshl_add_u32 v3, v244, 1, v3
    v_lshlrev_b32 v2, 4, v2
    v_mfma_f32_16x16x32_bf16 v[56:59], v[40:43], v[60:63], v[56:59]
    v_mfma_f32_32x32x16_bf16 v[116:131], v[60:63], a[88:91], v[116:131]
    ds_read_b64_tr_b16 v[68:69], v24 offset:24576
    ds_read_b64_tr_b16 v[70:71], v24 offset:25088
    s_add_u32 m0, s8, 114688
    s_add_u32 s88, s78, s6
    buffer_load_dwordx4 v6, s[28:31], s88 offen lds
    v_mfma_f32_32x32x16_bf16 v[132:147], v[60:63], a[216:219], v[132:147]
    buffer_load_dwordx4 v7, s[28:31], s88 offen offset:1024 lds
    s_waitcnt lgkmcnt(2)
    v_add_u32 v2, 1024, v2
    v_cndmask_b32 v18, v3, v2, s[16:17]
    v_add_u32 v3, 480, v3
    v_mfma_f32_32x32x16_bf16 v[116:131], v[64:67], a[92:95], v[116:131]
    ds_read_b64_tr_b16 v[60:61], v25 offset:24576
    ds_read_b64_tr_b16 v[62:63], v25 offset:25088
    v_cndmask_b32 v4, v3, v2, s[16:17]
    v_lshrrev_b32 v2, 3, v0
    v_and_b32 v3, 7, v0
    v_lshlrev_b32 v3, 4, v3
    v_mfma_f32_32x32x16_bf16 v[132:147], v[64:67], a[220:223], v[132:147]
    s_waitcnt lgkmcnt(2)
    v_lshl_add_u32 v19, v2, 10, v3
    v_mul_f32 v54, s13, v54
    v_mul_f32 v55, s13, v55
    v_mfma_f32_16x16x32_bf16 v[56:59], v[40:43], v[68:71], v[56:59]
    v_mfma_f32_32x32x16_bf16 v[116:131], v[68:71], a[96:99], v[116:131]
    ds_read_b64_tr_b16 v[64:65], v24 offset:28672
    ds_read_b64_tr_b16 v[66:67], v24 offset:29184
    v_mfma_f32_32x32x16_bf16 v[132:147], v[68:71], a[224:227], v[132:147]
    s_add_u32 m0, s8, 32768
    s_add_u32 s88, s79, s6
    buffer_load_dwordx4 v6, s[28:31], s88 offen lds
    s_waitcnt lgkmcnt(2)
    v_mfma_f32_32x32x16_bf16 v[116:131], v[60:63], a[100:103], v[116:131]
    ds_read_b64_tr_b16 v[68:69], v25 offset:28672
    ds_read_b64_tr_b16 v[70:71], v25 offset:29184
    buffer_load_dwordx4 v7, s[28:31], s88 offen offset:1024 lds
    v_mfma_f32_32x32x16_bf16 v[132:147], v[60:63], a[228:231], v[132:147]
    s_waitcnt vmcnt(16) lgkmcnt(2)
    s_barrier
    v_mfma_f32_16x16x32_bf16 v[56:59], v[40:43], v[64:67], v[56:59]
    v_mfma_f32_32x32x16_bf16 v[116:131], v[64:67], a[104:107], v[116:131]
    ds_read_b64_tr_b16 v[60:61], v20 offset:0
    ds_read_b64_tr_b16 v[62:63], v20 offset:512
    v_mfma_f32_32x32x16_bf16 v[132:147], v[64:67], a[232:235], v[132:147]
    s_waitcnt lgkmcnt(2)
    v_mfma_f32_32x32x16_bf16 v[116:131], v[68:71], a[108:111], v[116:131]
    ds_read_b64_tr_b16 v[64:65], v21 offset:0
    ds_read_b64_tr_b16 v[66:67], v21 offset:512
    s_add_u32 m0, s8, 40960
    s_xor_b32 s88, s12, 0
    s_add_u32 s88, s88, s97
    buffer_load_dwordx4 v10, s[44:47], s88 offen lds
    v_mfma_f32_32x32x16_bf16 v[132:147], v[68:71], a[236:239], v[132:147]
    buffer_load_dwordx4 v11, s[44:47], s88 offen offset:1024 lds
    v_cndmask_b32 v37, v56, v57, s[16:17]
    ds_write_b32 v26, v37
    s_waitcnt lgkmcnt(3)
    v_mfma_f32_16x16x32_bf16 v[56:59], v[40:43], v[60:63], v[56:59]
    v_mfma_f32_32x32x16_bf16 v[116:131], v[60:63], a[112:115], v[116:131]
    ds_read_b64_tr_b16 v[68:69], v20 offset:4096
    ds_read_b64_tr_b16 v[70:71], v20 offset:4608
    v_mfma_f32_32x32x16_bf16 v[132:147], v[60:63], a[240:243], v[132:147]
    s_waitcnt lgkmcnt(3)
    v_mfma_f32_16x16x32_bf16 v[56:59], v[40:43], v[64:67], v[56:59]
    v_mfma_f32_32x32x16_bf16 v[116:131], v[64:67], a[116:119], v[116:131]
    ds_read_b64_tr_b16 v[60:61], v21 offset:4096
    ds_read_b64_tr_b16 v[62:63], v21 offset:4608
    s_add_u32 m0, s8, 122880
    s_xor_b32 s88, s12, 16384
    s_add_u32 s88, s88, s97
    buffer_load_dwordx4 v10, s[44:47], s88 offen lds
    v_mfma_f32_32x32x16_bf16 v[132:147], v[64:67], a[244:247], v[132:147]
    buffer_load_dwordx4 v11, s[44:47], s88 offen offset:1024 lds
    s_waitcnt lgkmcnt(2)
    s_barrier
    v_mfma_f32_16x16x32_bf16 v[56:59], v[40:43], v[68:71], v[56:59]
    v_mfma_f32_32x32x16_bf16 v[116:131], v[68:71], a[120:123], v[116:131]
    ds_read_b64_tr_b16 v[64:65], v22 offset:16384
    ds_read_b64_tr_b16 v[66:67], v22 offset:16896
    v_mfma_f32_32x32x16_bf16 v[132:147], v[68:71], a[248:251], v[132:147]
    ds_read_b32 v36, v27
    s_add_u32 m0, s8, 65536
    s_xor_b32 s88, s12, 32768
    s_add_u32 s88, s88, s97
    buffer_load_dwordx4 v10, s[44:47], s88 offen lds
    s_waitcnt lgkmcnt(3)
    v_mfma_f32_16x16x32_bf16 v[56:59], v[40:43], v[60:63], v[56:59]
    v_mfma_f32_32x32x16_bf16 v[116:131], v[60:63], a[124:127], v[116:131]
    ds_read_b64_tr_b16 v[68:69], v23 offset:16384
    ds_read_b64_tr_b16 v[70:71], v23 offset:16896
    buffer_load_dwordx4 v11, s[44:47], s88 offen offset:1024 lds
    s_lshl_b32 s89, s56, 1
    s_add_u32 s89, s89, s60
    s_lshl_b32 s89, s89, 2
    s_lshr_b32 s90, s58, 1
    s_add_u32 s89, s89, s90
    s_lshl_b32 s89, s89, 4
    s_and_b32 s90, s58, 1
    s_lshl_b32 s90, s90, 1
    s_add_u32 s89, s89, s90
    s_add_u32 s89, s89, s61
    s_add_u32 s89, s89, 0
    s_lshl_b32 s89, s89, 3
    s_add_u32 s89, s89, 11534336
    v_mfma_f32_32x32x16_bf16 v[132:147], v[60:63], a[252:255], v[132:147]
    s_waitcnt lgkmcnt(3)
    s_waitcnt vmcnt(10)
    s_mov_b64 exec, 1
    buffer_store_dwordx2 v[250:251], v246, s[36:39], s89 offen sc1
    s_mov_b64 exec, -1
    s_waitcnt lgkmcnt(2)
    v_cndmask_b32 v38, v56, v57, s[16:17]
    v_mfma_f32_16x16x32_bf16 v[56:59], v[40:43], v[64:67], 0
    v_mfma_f32_32x32x16_bf16 v[84:99], v[64:67], a[0:3], 0
    ds_read_b64_tr_b16 v[60:61], v22 offset:20480
    ds_read_b64_tr_b16 v[62:63], v22 offset:20992
    s_add_u32 m0, s8, 73728
    s_xor_b32 s88, s12, 49152
    s_add_u32 s88, s88, s97
    buffer_load_dwordx4 v10, s[44:47], s88 offen lds
    v_mfma_f32_32x32x16_bf16 v[100:115], v[64:67], a[128:131], 0
    buffer_load_dwordx4 v11, s[44:47], s88 offen offset:1024 lds
    s_waitcnt lgkmcnt(2)
    v_add_f32 v38, v38, v36
    v_cvt_pk_bf16_f32 v212, -v38, -v38
    v_and_b32 v212, 0xffff0000, v212
    v_mfma_f32_32x32x16_bf16 v[84:99], v[68:71], a[4:7], v[84:99]
    ds_read_b64_tr_b16 v[64:65], v23 offset:20480
    ds_read_b64_tr_b16 v[66:67], v23 offset:20992
    v_sub_f32 v212, -v38, v212
    v_cvt_pk_bf16_f32 v212, -v38, v212
    v_cndmask_b32 v80, v212, 0, s[18:19]
    v_mfma_f32_32x32x16_bf16 v[100:115], v[68:71], a[132:135], v[100:115]
    s_waitcnt lgkmcnt(2)
    s_barrier
    v_mfma_f32_32x32x16_bf16 v[116:131], v[80:83], v[72:75], v[116:131]
    s_add_u32 m0, s8, 57344
    s_xor_b32 s88, s12, 65536
    s_add_u32 s88, s88, s97
    buffer_load_dwordx4 v10, s[44:47], s88 offen lds
    v_mfma_f32_32x32x16_bf16 v[132:147], v[80:83], v[76:79], v[132:147]
    buffer_load_dwordx4 v11, s[44:47], s88 offen offset:1024 lds
    v_mfma_f32_16x16x32_bf16 v[56:59], v[40:43], v[60:63], v[56:59]
    v_mfma_f32_32x32x16_bf16 v[84:99], v[60:63], a[8:11], v[84:99]
    ds_read_b64_tr_b16 v[68:69], v20 offset:49152
    ds_read_b64_tr_b16 v[70:71], v20 offset:49664
    v_mfma_f32_32x32x16_bf16 v[100:115], v[60:63], a[136:139], v[100:115]
    s_add_u32 m0, s8, 90112
    s_xor_b32 s88, s12, 81920
    s_add_u32 s88, s88, s97
    buffer_load_dwordx4 v10, s[44:47], s88 offen lds
    s_waitcnt lgkmcnt(2)
    v_pk_mul_f32 v[212:213], v[116:117], v[52:53] op_sel:[0,0] op_sel_hi:[1,0]
    v_pk_mul_f32 v[214:215], v[118:119], v[52:53] op_sel:[0,0] op_sel_hi:[1,0]
    v_pk_mul_f32 v[216:217], v[120:121], v[52:53] op_sel:[0,0] op_sel_hi:[1,0]
    v_pk_mul_f32 v[218:219], v[122:123], v[52:53] op_sel:[0,0] op_sel_hi:[1,0]
    v_pk_mul_f32 v[220:221], v[124:125], v[52:53] op_sel:[0,0] op_sel_hi:[1,0]
    v_pk_mul_f32 v[222:223], v[126:127], v[52:53] op_sel:[0,0] op_sel_hi:[1,0]
    v_pk_mul_f32 v[224:225], v[128:129], v[52:53] op_sel:[0,0] op_sel_hi:[1,0]
    v_pk_mul_f32 v[226:227], v[130:131], v[52:53] op_sel:[0,0] op_sel_hi:[1,0]
    v_pk_mul_f32 v[228:229], v[132:133], v[52:53] op_sel:[0,1] op_sel_hi:[1,1]
    v_pk_mul_f32 v[230:231], v[134:135], v[52:53] op_sel:[0,1] op_sel_hi:[1,1]
    v_pk_mul_f32 v[232:233], v[136:137], v[52:53] op_sel:[0,1] op_sel_hi:[1,1]
    v_pk_mul_f32 v[234:235], v[138:139], v[52:53] op_sel:[0,1] op_sel_hi:[1,1]
    v_pk_mul_f32 v[236:237], v[140:141], v[52:53] op_sel:[0,1] op_sel_hi:[1,1]
    v_pk_mul_f32 v[238:239], v[142:143], v[52:53] op_sel:[0,1] op_sel_hi:[1,1]
    v_pk_mul_f32 v[240:241], v[144:145], v[52:53] op_sel:[0,1] op_sel_hi:[1,1]
    v_pk_mul_f32 v[242:243], v[146:147], v[52:53] op_sel:[0,1] op_sel_hi:[1,1]
    buffer_load_dwordx4 v11, s[44:47], s88 offen offset:1024 lds
    v_mfma_f32_32x32x16_bf16 v[84:99], v[64:67], a[12:15], v[84:99]
    ds_read_b64_tr_b16 v[60:61], v21 offset:49152
    ds_read_b64_tr_b16 v[62:63], v21 offset:49664
    s_add_u32 m0, s8, 98304
    s_xor_b32 s88, s12, 98304
    s_add_u32 s88, s88, s97
    buffer_load_dwordx4 v10, s[44:47], s88 offen lds
    v_mfma_f32_32x32x16_bf16 v[100:115], v[64:67], a[140:143], v[100:115]
    buffer_load_dwordx4 v11, s[44:47], s88 offen offset:1024 lds
    s_waitcnt lgkmcnt(2)
    v_exp_f32_e64 v212, v212 clamp
    v_max_f32 v116, v54, v116
    v_mfma_f32_16x16x32_bf16 v[56:59], v[40:43], v[68:71], v[56:59]
    v_mfma_f32_32x32x16_bf16 v[84:99], v[68:71], a[16:19], v[84:99]
    ds_read_b64_tr_b16 v[64:65], v20 offset:53248
    ds_read_b64_tr_b16 v[66:67], v20 offset:53760
    s_add_u32 m0, s8, 147456
    s_xor_b32 s88, s12, 114688
    s_add_u32 s88, s88, s97
    buffer_load_dwordx4 v10, s[44:47], s88 offen lds
    v_exp_f32_e64 v213, v213 clamp
    v_max_f32 v117, v54, v117
    v_mfma_f32_32x32x16_bf16 v[100:115], v[68:71], a[144:147], v[100:115]
    buffer_load_dwordx4 v11, s[44:47], s88 offen offset:1024 lds
    s_waitcnt lgkmcnt(2)
    v_exp_f32_e64 v214, v214 clamp
    v_max_f32 v118, v54, v118
    v_exp_f32_e64 v215, v215 clamp
    v_max_f32 v119, v54, v119
    v_mfma_f32_32x32x16_bf16 v[84:99], v[60:63], a[20:23], v[84:99]
    ds_read_b64_tr_b16 v[68:69], v21 offset:53248
    ds_read_b64_tr_b16 v[70:71], v21 offset:53760
    v_exp_f32_e64 v216, v216 clamp
    v_max_f32 v120, v54, v120
    v_exp_f32_e64 v217, v217 clamp
    v_max_f32 v121, v54, v121
    v_exp_f32_e64 v218, v218 clamp
    v_mfma_f32_32x32x16_bf16 v[100:115], v[60:63], a[148:151], v[100:115]
    s_add_u32 m0, s8, 155648
    s_xor_b32 s88, s12, 0
    s_add_u32 s88, s88, s98
    buffer_load_dwordx4 v10, s[48:51], s88 offen lds
    s_waitcnt lgkmcnt(2)
    s_barrier
    v_max_f32 v122, v54, v122
    v_exp_f32_e64 v219, v219 clamp
    v_mfma_f32_16x16x32_bf16 v[56:59], v[40:43], v[64:67], v[56:59]
    v_mfma_f32_32x32x16_bf16 v[84:99], v[64:67], a[24:27], v[84:99]
    ds_read_b64_tr_b16 v[60:61], v20 offset:8192
    ds_read_b64_tr_b16 v[62:63], v20 offset:8704
    buffer_load_dwordx4 v11, s[48:51], s88 offen offset:1024 lds
    v_max_f32 v123, v54, v123
    v_exp_f32_e64 v220, v220 clamp
    v_max_f32 v124, v54, v124
    v_exp_f32_e64 v221, v221 clamp
    v_mfma_f32_32x32x16_bf16 v[100:115], v[64:67], a[152:155], v[100:115]
    s_waitcnt lgkmcnt(2)
    v_max_f32 v125, v54, v125
    v_exp_f32_e64 v222, v222 clamp
    v_max_f32 v126, v54, v126
    v_exp_f32_e64 v223, v223 clamp
    v_max_f32 v127, v54, v127
    v_mfma_f32_32x32x16_bf16 v[84:99], v[68:71], a[28:31], v[84:99]
    ds_read_b64_tr_b16 v[64:65], v21 offset:8192
    ds_read_b64_tr_b16 v[66:67], v21 offset:8704
    s_add_u32 m0, s8, 0
    s_xor_b32 s88, s12, 16384
    s_add_u32 s88, s88, s98
    buffer_load_dwordx4 v10, s[48:51], s88 offen lds
    v_exp_f32_e64 v224, v224 clamp
    v_max_f32 v128, v54, v128
    v_mfma_f32_32x32x16_bf16 v[100:115], v[68:71], a[156:159], v[100:115]
    buffer_load_dwordx4 v11, s[48:51], s88 offen offset:1024 lds
    s_waitcnt lgkmcnt(2)
    v_exp_f32_e64 v225, v225 clamp
    v_max_f32 v129, v54, v129
    v_exp_f32_e64 v226, v226 clamp
    v_max_f32 v130, v54, v130
    v_mfma_f32_16x16x32_bf16 v[56:59], v[40:43], v[60:63], v[56:59]
    v_mfma_f32_32x32x16_bf16 v[84:99], v[60:63], a[32:35], v[84:99]
    ds_read_b64_tr_b16 v[68:69], v20 offset:12288
    ds_read_b64_tr_b16 v[70:71], v20 offset:12800
    s_add_u32 m0, s8, 81920
    s_xor_b32 s88, s12, 32768
    s_add_u32 s88, s88, s98
    buffer_load_dwordx4 v10, s[48:51], s88 offen lds
    v_exp_f32_e64 v227, v227 clamp
    v_max_f32 v131, v54, v131
    v_mfma_f32_32x32x16_bf16 v[100:115], v[60:63], a[160:163], v[100:115]
    buffer_load_dwordx4 v11, s[48:51], s88 offen offset:1024 lds
    s_waitcnt lgkmcnt(2)
    v_exp_f32_e64 v228, v228 clamp
    v_max_f32 v132, v55, v132
    v_exp_f32_e64 v229, v229 clamp
    v_max_f32 v133, v55, v133
    v_mfma_f32_32x32x16_bf16 v[84:99], v[64:67], a[36:39], v[84:99]
    ds_read_b64_tr_b16 v[60:61], v21 offset:12288
    ds_read_b64_tr_b16 v[62:63], v21 offset:12800
    v_exp_f32_e64 v230, v230 clamp
    v_max_f32 v134, v55, v134
    v_exp_f32_e64 v231, v231 clamp
    v_max_f32 v135, v55, v135
    v_exp_f32_e64 v232, v232 clamp
    v_mfma_f32_32x32x16_bf16 v[100:115], v[64:67], a[164:167], v[100:115]
    s_waitcnt lgkmcnt(2)
    s_barrier
    buffer_load_dwordx2 v[248:249], v244, s[36:39], s2 offen sc1
    v_max_f32 v136, v55, v136
    v_exp_f32_e64 v233, v233 clamp
    v_max_f32 v137, v55, v137
    v_exp_f32_e64 v234, v234 clamp
    v_max_f32 v138, v55, v138
    v_mfma_f32_16x16x32_bf16 v[56:59], v[40:43], v[68:71], v[56:59]
    v_mfma_f32_32x32x16_bf16 v[84:99], v[68:71], a[40:43], v[84:99]
    ds_read_b64_tr_b16 v[64:65], v22 offset:40960
    ds_read_b64_tr_b16 v[66:67], v22 offset:41472
    s_add_u32 m0, s8, 49152
    s_xor_b32 s88, s12, 49152
    s_add_u32 s88, s88, s98
    buffer_load_dwordx4 v10, s[48:51], s88 offen lds
    v_exp_f32_e64 v235, v235 clamp
    v_max_f32 v139, v55, v139
    v_mfma_f32_32x32x16_bf16 v[100:115], v[68:71], a[168:171], v[100:115]
    buffer_load_dwordx4 v11, s[48:51], s88 offen offset:1024 lds
    s_waitcnt lgkmcnt(2)
    v_exp_f32_e64 v236, v236 clamp
    v_max_f32 v140, v55, v140
    v_exp_f32_e64 v237, v237 clamp
    v_max_f32 v141, v55, v141
    v_mfma_f32_32x32x16_bf16 v[84:99], v[60:63], a[44:47], v[84:99]
    ds_read_b64_tr_b16 v[68:69], v23 offset:40960
    ds_read_b64_tr_b16 v[70:71], v23 offset:41472
    v_exp_f32_e64 v238, v238 clamp
    v_max_f32 v142, v55, v142
    v_exp_f32_e64 v239, v239 clamp
    v_max_f32 v143, v55, v143
    v_exp_f32_e64 v240, v240 clamp
    v_mfma_f32_32x32x16_bf16 v[100:115], v[60:63], a[172:175], v[100:115]
    s_waitcnt lgkmcnt(2)
    v_max_f32 v144, v55, v144
    v_exp_f32_e64 v241, v241 clamp
    v_max_f32 v145, v55, v145
    v_exp_f32_e64 v242, v242 clamp
    v_max_f32 v146, v55, v146
    v_mfma_f32_16x16x32_bf16 v[56:59], v[40:43], v[64:67], v[56:59]
    v_mfma_f32_32x32x16_bf16 v[84:99], v[64:67], a[48:51], v[84:99]
    ds_read_b64_tr_b16 v[60:61], v22 offset:45056
    ds_read_b64_tr_b16 v[62:63], v22 offset:45568
    s_waitcnt vmcnt(24)
    ds_read_b64_tr_b16 a[32:33], v12 offset:40960
    ds_read_b64_tr_b16 a[34:35], v12 offset:41984
    v_exp_f32_e64 v243, v243 clamp
    v_max_f32 v147, v55, v147
    v_mfma_f32_32x32x16_bf16 v[100:115], v[64:67], a[176:179], v[100:115]
    s_waitcnt lgkmcnt(4)
    v_pk_fma_f32 v[116:117], v[116:117], v[34:35], v[212:213] op_sel:[0,0,0] op_sel_hi:[1,0,1]
    v_pk_fma_f32 v[118:119], v[118:119], v[34:35], v[214:215] op_sel:[0,0,0] op_sel_hi:[1,0,1]
    v_pk_fma_f32 v[120:121], v[120:121], v[34:35], v[216:217] op_sel:[0,0,0] op_sel_hi:[1,0,1]
    v_pk_fma_f32 v[122:123], v[122:123], v[34:35], v[218:219] op_sel:[0,0,0] op_sel_hi:[1,0,1]
    v_pk_fma_f32 v[124:125], v[124:125], v[34:35], v[220:221] op_sel:[0,0,0] op_sel_hi:[1,0,1]
    v_pk_fma_f32 v[126:127], v[126:127], v[34:35], v[222:223] op_sel:[0,0,0] op_sel_hi:[1,0,1]
    v_pk_fma_f32 v[128:129], v[128:129], v[34:35], v[224:225] op_sel:[0,0,0] op_sel_hi:[1,0,1]
    v_pk_fma_f32 v[130:131], v[130:131], v[34:35], v[226:227] op_sel:[0,0,0] op_sel_hi:[1,0,1]
    v_pk_fma_f32 v[132:133], v[132:133], v[34:35], v[228:229] op_sel:[0,1,0] op_sel_hi:[1,1,1]
    v_pk_fma_f32 v[134:135], v[134:135], v[34:35], v[230:231] op_sel:[0,1,0] op_sel_hi:[1,1,1]
    v_pk_fma_f32 v[136:137], v[136:137], v[34:35], v[232:233] op_sel:[0,1,0] op_sel_hi:[1,1,1]
    v_pk_fma_f32 v[138:139], v[138:139], v[34:35], v[234:235] op_sel:[0,1,0] op_sel_hi:[1,1,1]
    v_pk_fma_f32 v[140:141], v[140:141], v[34:35], v[236:237] op_sel:[0,1,0] op_sel_hi:[1,1,1]
    v_pk_fma_f32 v[142:143], v[142:143], v[34:35], v[238:239] op_sel:[0,1,0] op_sel_hi:[1,1,1]
    v_pk_fma_f32 v[144:145], v[144:145], v[34:35], v[240:241] op_sel:[0,1,0] op_sel_hi:[1,1,1]
    v_pk_fma_f32 v[146:147], v[146:147], v[34:35], v[242:243] op_sel:[0,1,0] op_sel_hi:[1,1,1]
    v_mfma_f32_32x32x16_bf16 v[84:99], v[68:71], a[52:55], v[84:99]
    ds_read_b64_tr_b16 v[64:65], v23 offset:45056
    ds_read_b64_tr_b16 v[66:67], v23 offset:45568
    ds_read_b64_tr_b16 a[36:37], v13 offset:40960
    ds_read_b64_tr_b16 a[38:39], v13 offset:41984
    v_cvt_pk_bf16_f32 v196, v116, v117
    v_cvt_pk_bf16_f32 v197, v118, v119
    v_cvt_pk_bf16_f32 v198, v120, v121
    v_cvt_pk_bf16_f32 v199, v122, v123
    v_cvt_pk_bf16_f32 v200, v124, v125
    v_cvt_pk_bf16_f32 v201, v126, v127
    v_mfma_f32_32x32x16_bf16 v[100:115], v[68:71], a[180:183], v[100:115]
    s_waitcnt lgkmcnt(6)
    s_barrier
    v_cvt_pk_bf16_f32 v202, v128, v129
    v_cvt_pk_bf16_f32 v203, v130, v131
    v_cvt_pk_bf16_f32 v204, v132, v133
    v_cvt_pk_bf16_f32 v205, v134, v135
    v_cvt_pk_bf16_f32 v206, v136, v137
    v_cvt_pk_bf16_f32 v207, v138, v139
    v_cvt_pk_bf16_f32 v208, v140, v141
    v_cvt_pk_bf16_f32 v209, v142, v143
    v_mfma_f32_16x16x32_bf16 v[56:59], v[40:43], v[60:63], v[56:59]
    v_mfma_f32_32x32x16_bf16 v[84:99], v[60:63], a[56:59], v[84:99]
    ds_read_b64_tr_b16 v[68:69], v20 offset:16384
    ds_read_b64_tr_b16 v[70:71], v20 offset:16896
    s_mul_i32 s9, s10, 32768
    s_add_u32 s9, s9, s95
    buffer_store_dwordx4 v[196:199], v28, s[36:39], s9 offen sc1
    s_waitcnt vmcnt(23)
    ds_read_b64_tr_b16 a[40:41], v14 offset:57344
    ds_read_b64_tr_b16 a[42:43], v14 offset:58368
    v_cvt_pk_bf16_f32 v210, v144, v145
    v_cvt_pk_bf16_f32 v211, v146, v147
    v_mfma_f32_32x32x16_bf16 v[100:115], v[60:63], a[184:187], v[100:115]
    buffer_store_dwordx4 v[200:203], v28, s[36:39], s9 offen offset:1024 sc1
    s_waitcnt lgkmcnt(6)
    v_mfma_f32_32x32x16_bf16 v[84:99], v[64:67], a[60:63], v[84:99]
    ds_read_b64_tr_b16 v[60:61], v21 offset:16384
    ds_read_b64_tr_b16 v[62:63], v21 offset:16896
    s_mul_i32 s9, s11, 32768
    s_add_u32 s9, s9, s95
    buffer_store_dwordx4 v[204:207], v28, s[36:39], s9 offen sc1
    ds_read_b64_tr_b16 a[44:45], v15 offset:57344
    ds_read_b64_tr_b16 a[46:47], v15 offset:58368
    v_mfma_f32_32x32x16_bf16 v[100:115], v[64:67], a[188:191], v[100:115]
    buffer_store_dwordx4 v[208:211], v28, s[36:39], s9 offen offset:1024 sc1
    s_waitcnt lgkmcnt(6)
    v_mfma_f32_16x16x32_bf16 v[56:59], v[40:43], v[68:71], v[56:59]
    v_mfma_f32_32x32x16_bf16 v[84:99], v[68:71], a[64:67], v[84:99]
    ds_read_b64_tr_b16 v[64:65], v20 offset:20480
    ds_read_b64_tr_b16 v[66:67], v20 offset:20992
    s_waitcnt vmcnt(24)
    ds_read_b64_tr_b16 a[160:161], v14 offset:0
    ds_read_b64_tr_b16 a[162:163], v14 offset:1024
    v_mfma_f32_32x32x16_bf16 v[100:115], v[68:71], a[192:195], v[100:115]
    s_add_u32 m0, s8, 8192
    s_xor_b32 s88, s12, 65536
    s_add_u32 s88, s88, s98
    buffer_load_dwordx4 v10, s[48:51], s88 offen lds
    s_waitcnt lgkmcnt(6)
    v_mfma_f32_32x32x16_bf16 v[84:99], v[60:63], a[68:71], v[84:99]
    ds_read_b64_tr_b16 v[68:69], v21 offset:20480
    ds_read_b64_tr_b16 v[70:71], v21 offset:20992
    buffer_load_dwordx4 v11, s[48:51], s88 offen offset:1024 lds
    ds_read_b64_tr_b16 a[164:165], v15 offset:0
    ds_read_b64_tr_b16 a[166:167], v15 offset:1024
    v_mfma_f32_32x32x16_bf16 v[100:115], v[60:63], a[196:199], v[100:115]
    s_waitcnt lgkmcnt(6)
    s_barrier
    s_waitcnt vmcnt(8)
    s_mov_b32 s90, 0
    v_cmp_eq_u64 vcc, v[248:249], s[92:93]
    s_nop 1
    s_and_b32 vcc_lo, vcc_lo, 15
    s_cmp_eq_u32 vcc_lo, 15
    s_cbranch_scc1 L_POK6
L_PL6:
    s_sleep 2
    buffer_load_dwordx2 v[248:249], v244, s[36:39], s2 offen sc1
    s_waitcnt vmcnt(0)
    s_add_u32 s90, s90, 1
    s_cmp_gt_u32 s90, 200000
    s_cbranch_scc1 L_POK6
    v_cmp_eq_u64 vcc, v[248:249], s[92:93]
    s_nop 1
    s_and_b32 vcc_lo, vcc_lo, 15
    s_cmp_eq_u32 vcc_lo, 15
    s_cbranch_scc0 L_PL6
L_POK6:
    s_nop 4
    v_mfma_f32_16x16x32_bf16 v[56:59], v[40:43], v[64:67], v[56:59]
    v_mfma_f32_32x32x16_bf16 v[84:99], v[64:67], a[72:75], v[84:99]
    ds_read_b64_tr_b16 v[60:61], v20 offset:24576
    ds_read_b64_tr_b16 v[62:63], v20 offset:25088
    s_xor_b32 s9, s64, 0
    buffer_load_dwordx4 a[0:3], v28, s[36:39], s9 offen sc1
    ds_read_b64_tr_b16 a[168:169], v14 offset:8192
    ds_read_b64_tr_b16 a[170:171], v14 offset:9216
    v_mfma_f32_32x32x16_bf16 v[100:115], v[64:67], a[200:203], v[100:115]
    s_xor_b32 s9, s64, 131072
    buffer_load_dwordx4 a[4:7], v28, s[36:39], s9 offen sc1
    s_waitcnt lgkmcnt(6)
    v_mfma_f32_32x32x16_bf16 v[84:99], v[68:71], a[76:79], v[84:99]
    ds_read_b64_tr_b16 v[64:65], v21 offset:24576
    ds_read_b64_tr_b16 v[66:67], v21 offset:25088
    s_xor_b32 s9, s64, 1024
    buffer_load_dwordx4 a[8:11], v28, s[36:39], s9 offen sc1
    ds_read_b64_tr_b16 a[172:173], v15 offset:8192
    ds_read_b64_tr_b16 a[174:175], v15 offset:9216
    v_mfma_f32_32x32x16_bf16 v[100:115], v[68:71], a[204:207], v[100:115]
    s_waitcnt lgkmcnt(6)
    v_mfma_f32_16x16x32_bf16 v[56:59], v[40:43], v[60:63], v[56:59]
    v_mfma_f32_32x32x16_bf16 v[84:99], v[60:63], a[80:83], v[84:99]
    ds_read_b64_tr_b16 v[68:69], v20 offset:28672
    ds_read_b64_tr_b16 v[70:71], v20 offset:29184
    s_xor_b32 s9, s64, 132096
    buffer_load_dwordx4 a[12:15], v28, s[36:39], s9 offen sc1
    ds_read_b64_tr_b16 a[48:49], v12 offset:57344
    ds_read_b64_tr_b16 a[50:51], v12 offset:58368
    v_mfma_f32_32x32x16_bf16 v[100:115], v[60:63], a[208:211], v[100:115]
    s_xor_b32 s9, s64, 2048
    buffer_load_dwordx4 a[128:131], v28, s[36:39], s9 offen sc1
    s_waitcnt lgkmcnt(6)
    v_mfma_f32_32x32x16_bf16 v[84:99], v[64:67], a[84:87], v[84:99]
    ds_read_b64_tr_b16 v[60:61], v21 offset:28672
    ds_read_b64_tr_b16 v[62:63], v21 offset:29184
    ds_read_b64_tr_b16 a[52:53], v13 offset:57344
    ds_read_b64_tr_b16 a[54:55], v13 offset:58368
    v_mfma_f32_32x32x16_bf16 v[100:115], v[64:67], a[212:215], v[100:115]
    s_xor_b32 s9, s64, 133120
    buffer_load_dwordx4 a[132:135], v28, s[36:39], s9 offen sc1
    s_waitcnt lgkmcnt(6)
    s_barrier
    v_mfma_f32_16x16x32_bf16 v[56:59], v[40:43], v[68:71], v[56:59]
    v_mfma_f32_32x32x16_bf16 v[84:99], v[68:71], a[88:91], v[84:99]
    ds_read_b64_tr_b16 v[64:65], v22 offset:49152
    ds_read_b64_tr_b16 v[66:67], v22 offset:49664
    s_xor_b32 s9, s64, 3072
    buffer_load_dwordx4 a[136:139], v28, s[36:39], s9 offen sc1
    ds_read_b64_tr_b16 a[56:57], v14 offset:24576
    ds_read_b64_tr_b16 a[58:59], v14 offset:25600
    v_mfma_f32_32x32x16_bf16 v[100:115], v[68:71], a[216:219], v[100:115]
    s_xor_b32 s9, s64, 134144
    buffer_load_dwordx4 a[140:143], v28, s[36:39], s9 offen sc1
    s_waitcnt lgkmcnt(6)
    v_mfma_f32_32x32x16_bf16 v[84:99], v[60:63], a[92:95], v[84:99]
    ds_read_b64_tr_b16 v[68:69], v23 offset:49152
    ds_read_b64_tr_b16 v[70:71], v23 offset:49664
    ds_read_b64_tr_b16 a[60:61], v15 offset:24576
    ds_read_b64_tr_b16 a[62:63], v15 offset:25600
    v_mfma_f32_32x32x16_bf16 v[100:115], v[60:63], a[220:223], v[100:115]
    s_xor_b32 s9, s64, 4096
    buffer_load_dwordx4 a[16:19], v28, s[36:39], s9 offen sc1
    s_waitcnt lgkmcnt(6)
    v_mfma_f32_16x16x32_bf16 v[56:59], v[40:43], v[64:67], v[56:59]
    v_mfma_f32_32x32x16_bf16 v[84:99], v[64:67], a[96:99], v[84:99]
    ds_read_b64_tr_b16 v[60:61], v22 offset:53248
    ds_read_b64_tr_b16 v[62:63], v22 offset:53760
    s_xor_b32 s9, s64, 135168
    buffer_load_dwordx4 a[20:23], v28, s[36:39], s9 offen sc1
    ds_read_b64_tr_b16 a[176:177], v14 offset:32768
    ds_read_b64_tr_b16 a[178:179], v14 offset:33792
    v_mfma_f32_32x32x16_bf16 v[100:115], v[64:67], a[224:227], v[100:115]
    s_xor_b32 s9, s64, 5120
    buffer_load_dwordx4 a[24:27], v28, s[36:39], s9 offen sc1
    s_waitcnt lgkmcnt(6)
    v_mfma_f32_32x32x16_bf16 v[84:99], v[68:71], a[100:103], v[84:99]
    ds_read_b64_tr_b16 v[64:65], v23 offset:53248
    ds_read_b64_tr_b16 v[66:67], v23 offset:53760
    ds_read_b64_tr_b16 a[180:181], v15 offset:32768
    ds_read_b64_tr_b16 a[182:183], v15 offset:33792
    v_mfma_f32_32x32x16_bf16 v[100:115], v[68:71], a[228:231], v[100:115]
    s_xor_b32 s9, s64, 136192
    buffer_load_dwordx4 a[28:31], v28, s[36:39], s9 offen sc1
    s_waitcnt lgkmcnt(6)
    s_barrier
    v_mfma_f32_16x16x32_bf16 v[56:59], v[40:43], v[60:63], v[56:59]
    v_mfma_f32_32x32x16_bf16 v[84:99], v[60:63], a[104:107], v[84:99]
    ds_read_b64_tr_b16 v[68:69], v20 offset:32768
    ds_read_b64_tr_b16 v[70:71], v20 offset:33280
    s_xor_b32 s9, s64, 6144
    buffer_load_dwordx4 a[144:147], v28, s[36:39], s9 offen sc1
    ds_read_b64_tr_b16 a[184:185], v16 offset:16384
    ds_read_b64_tr_b16 a[186:187], v16 offset:17408
    v_mfma_f32_32x32x16_bf16 v[100:115], v[60:63], a[232:235], v[100:115]
    s_waitcnt lgkmcnt(6)
    v_mfma_f32_32x32x16_bf16 v[84:99], v[64:67], a[108:111], v[84:99]
    ds_read_b64_tr_b16 v[60:61], v21 offset:32768
    ds_read_b64_tr_b16 v[62:63], v21 offset:33280
    s_xor_b32 s9, s64, 137216
    buffer_load_dwordx4 a[148:151], v28, s[36:39], s9 offen sc1
    ds_read_b64_tr_b16 a[188:189], v17 offset:16384
    ds_read_b64_tr_b16 a[190:191], v17 offset:17408
    v_mfma_f32_32x32x16_bf16 v[100:115], v[64:67], a[236:239], v[100:115]
    s_xor_b32 s9, s64, 7168
    buffer_load_dwordx4 a[152:155], v28, s[36:39], s9 offen sc1
    v_cndmask_b32 v37, v56, v57, s[16:17]
    ds_write_b32 v26, v37
    s_waitcnt lgkmcnt(7)
    v_mfma_f32_16x16x32_bf16 v[56:59], v[40:43], v[68:71], v[56:59]
    v_mfma_f32_32x32x16_bf16 v[84:99], v[68:71], a[112:115], v[84:99]
    ds_read_b64_tr_b16 v[64:65], v20 offset:36864
    ds_read_b64_tr_b16 v[66:67], v20 offset:37376
    s_xor_b32 s9, s64, 138240
    buffer_load_dwordx4 a[156:159], v28, s[36:39], s9 offen sc1
    s_lshl_b32 s89, s56, 1
    s_add_u32 s89, s89, s60
    s_lshl_b32 s89, s89, 2
    s_lshr_b32 s90, s58, 1
    s_add_u32 s89, s89, s90
    s_lshl_b32 s89, s89, 4
    s_and_b32 s90, s58, 1
    s_lshl_b32 s90, s90, 1
    s_add_u32 s89, s89, s90
    s_add_u32 s89, s89, s61
    s_add_u32 s89, s89, 4
    s_lshl_b32 s89, s89, 3
    s_add_u32 s89, s89, 11534336
    v_mfma_f32_32x32x16_bf16 v[100:115], v[68:71], a[240:243], v[100:115]
    s_waitcnt lgkmcnt(5)
    s_waitcnt vmcnt(18)
    s_mov_b64 exec, 1
    buffer_store_dwordx2 v[250:251], v246, s[36:39], s89 offen sc1
    s_mov_b64 exec, -1
    v_mfma_f32_16x16x32_bf16 v[56:59], v[40:43], v[60:63], v[56:59]
    v_mfma_f32_32x32x16_bf16 v[84:99], v[60:63], a[116:119], v[84:99]
    ds_read_b64_tr_b16 v[68:69], v21 offset:36864
    ds_read_b64_tr_b16 v[70:71], v21 offset:37376
    s_add_u32 m0, s8, 40960
    s_xor_b32 s88, s12, 81920
    s_add_u32 s88, s88, s98
    buffer_load_dwordx4 v10, s[48:51], s88 offen lds
    v_mfma_f32_32x32x16_bf16 v[100:115], v[60:63], a[244:247], v[100:115]
    buffer_load_dwordx4 v11, s[48:51], s88 offen offset:1024 lds
    s_waitcnt lgkmcnt(2)
    s_barrier
    v_mfma_f32_16x16x32_bf16 v[56:59], v[40:43], v[64:67], v[56:59]
    v_mfma_f32_32x32x16_bf16 v[84:99], v[64:67], a[120:123], v[84:99]
    s_add_u32 m0, s8, 106496
    s_xor_b32 s88, s12, 98304
    s_add_u32 s88, s88, s98
    buffer_load_dwordx4 v10, s[48:51], s88 offen lds
    v_mfma_f32_32x32x16_bf16 v[100:115], v[64:67], a[248:251], v[100:115]
    ds_read_b32 v36, v27
    buffer_load_dwordx4 v11, s[48:51], s88 offen offset:1024 lds
    s_waitcnt lgkmcnt(1)
    v_mfma_f32_16x16x32_bf16 v[56:59], v[40:43], v[68:71], v[56:59]
    v_mfma_f32_32x32x16_bf16 v[84:99], v[68:71], a[124:127], v[84:99]
    v_mfma_f32_32x32x16_bf16 v[100:115], v[68:71], a[252:255], v[100:115]
    s_add_u32 m0, s8, 122880
    s_xor_b32 s88, s12, 114688
    s_add_u32 s88, s88, s98
    buffer_load_dwordx4 v10, s[48:51], s88 offen lds
    buffer_load_dwordx4 v11, s[48:51], s88 offen offset:1024 lds
    s_waitcnt lgkmcnt(0)
    v_cndmask_b32 v38, v56, v57, s[16:17]
    v_add_f32 v38, v38, v36
    v_cvt_pk_bf16_f32 v212, -v38, -v38
    v_and_b32 v212, 0xffff0000, v212
    v_sub_f32 v212, -v38, v212
    v_cvt_pk_bf16_f32 v212, -v38, v212
    v_cndmask_b32 v80, v212, 0, s[18:19]
    s_nop 1
    v_mfma_f32_32x32x16_bf16 v[84:99], v[80:83], v[72:75], v[84:99]
    v_mfma_f32_32x32x16_bf16 v[100:115], v[80:83], v[76:79], v[100:115]
    s_nop 10
    v_pk_mul_f32 v[84:85], v[84:85], v[34:35] op_sel:[0,0] op_sel_hi:[1,0]
    v_pk_mul_f32 v[86:87], v[86:87], v[34:35] op_sel:[0,0] op_sel_hi:[1,0]
    v_pk_mul_f32 v[88:89], v[88:89], v[34:35] op_sel:[0,0] op_sel_hi:[1,0]
    v_pk_mul_f32 v[90:91], v[90:91], v[34:35] op_sel:[0,0] op_sel_hi:[1,0]
    v_pk_mul_f32 v[92:93], v[92:93], v[34:35] op_sel:[0,0] op_sel_hi:[1,0]
    v_pk_mul_f32 v[94:95], v[94:95], v[34:35] op_sel:[0,0] op_sel_hi:[1,0]
    v_pk_mul_f32 v[96:97], v[96:97], v[34:35] op_sel:[0,0] op_sel_hi:[1,0]
    v_pk_mul_f32 v[98:99], v[98:99], v[34:35] op_sel:[0,0] op_sel_hi:[1,0]
    v_cvt_pk_bf16_f32 v196, v84, v85
    v_cvt_pk_bf16_f32 v197, v86, v87
    v_cvt_pk_bf16_f32 v198, v88, v89
    v_cvt_pk_bf16_f32 v199, v90, v91
    v_pk_max_i16 v196, v196, 0
    v_pk_max_i16 v197, v197, 0
    v_pk_max_i16 v198, v198, 0
    v_pk_max_i16 v199, v199, 0
    s_mul_i32 s9, s10, 131072
    s_add_u32 s9, s9, s96
    buffer_store_dwordx4 v[196:199], v28, s[36:39], s9 offen sc1
    v_cvt_pk_bf16_f32 v200, v92, v93
    v_cvt_pk_bf16_f32 v201, v94, v95
    v_cvt_pk_bf16_f32 v202, v96, v97
    v_cvt_pk_bf16_f32 v203, v98, v99
    v_pk_max_i16 v200, v200, 0
    v_pk_max_i16 v201, v201, 0
    v_pk_max_i16 v202, v202, 0
    v_pk_max_i16 v203, v203, 0
    buffer_store_dwordx4 v[200:203], v28, s[36:39], s9 offen offset:1024 sc1
    v_pk_mul_f32 v[100:101], v[100:101], v[34:35] op_sel:[0,1] op_sel_hi:[1,1]
    v_pk_mul_f32 v[102:103], v[102:103], v[34:35] op_sel:[0,1] op_sel_hi:[1,1]
    v_pk_mul_f32 v[104:105], v[104:105], v[34:35] op_sel:[0,1] op_sel_hi:[1,1]
    v_pk_mul_f32 v[106:107], v[106:107], v[34:35] op_sel:[0,1] op_sel_hi:[1,1]
    v_pk_mul_f32 v[108:109], v[108:109], v[34:35] op_sel:[0,1] op_sel_hi:[1,1]
    v_pk_mul_f32 v[110:111], v[110:111], v[34:35] op_sel:[0,1] op_sel_hi:[1,1]
    v_pk_mul_f32 v[112:113], v[112:113], v[34:35] op_sel:[0,1] op_sel_hi:[1,1]
    v_pk_mul_f32 v[114:115], v[114:115], v[34:35] op_sel:[0,1] op_sel_hi:[1,1]
    v_cvt_pk_bf16_f32 v204, v100, v101
    v_cvt_pk_bf16_f32 v205, v102, v103
    v_cvt_pk_bf16_f32 v206, v104, v105
    v_cvt_pk_bf16_f32 v207, v106, v107
    v_pk_max_i16 v204, v204, 0
    v_pk_max_i16 v205, v205, 0
    v_pk_max_i16 v206, v206, 0
    v_pk_max_i16 v207, v207, 0
    s_mul_i32 s9, s11, 131072
    s_add_u32 s9, s9, s96
    buffer_store_dwordx4 v[204:207], v28, s[36:39], s9 offen sc1
    v_cvt_pk_bf16_f32 v208, v108, v109
    v_cvt_pk_bf16_f32 v209, v110, v111
    v_cvt_pk_bf16_f32 v210, v112, v113
    v_cvt_pk_bf16_f32 v211, v114, v115
    v_pk_max_i16 v208, v208, 0
    v_pk_max_i16 v209, v209, 0
    v_pk_max_i16 v210, v210, 0
    v_pk_max_i16 v211, v211, 0
    buffer_store_dwordx4 v[208:211], v28, s[36:39], s9 offen offset:1024 sc1
    s_waitcnt lgkmcnt(0)
    s_barrier
    s_waitcnt vmcnt(25)
    v_mfma_f32_32x32x16_bf16 v[116:131], a[32:35], a[0:3], 0
    v_mfma_f32_32x32x16_bf16 v[148:163], a[36:39], a[0:3], 0
    v_mfma_f32_32x32x16_bf16 v[132:147], a[32:35], a[4:7], 0
    v_mfma_f32_32x32x16_bf16 v[164:179], a[36:39], a[4:7], 0
    s_add_u32 m0, s8, 65536
    s_xor_b32 s88, s12, 131072
    s_add_u32 s88, s88, s97
    buffer_load_dwordx4 v10, s[44:47], s88 offen lds
    s_waitcnt vmcnt(24)
    v_mfma_f32_32x32x16_bf16 v[116:131], a[40:43], a[8:11], v[116:131]
    buffer_load_dwordx4 v11, s[44:47], s88 offen offset:1024 lds
    v_mfma_f32_32x32x16_bf16 v[148:163], a[44:47], a[8:11], v[148:163]
    v_mfma_f32_32x32x16_bf16 v[132:147], a[40:43], a[12:15], v[132:147]
    v_mfma_f32_32x32x16_bf16 v[164:179], a[44:47], a[12:15], v[164:179]
    s_add_u32 m0, s8, 16384
    s_xor_b32 s88, s12, 147456
    s_add_u32 s88, s88, s97
    buffer_load_dwordx4 v10, s[44:47], s88 offen lds
    s_waitcnt vmcnt(24)
    v_mfma_f32_32x32x16_bf16 v[116:131], a[160:163], a[128:131], v[116:131]
    buffer_load_dwordx4 v11, s[44:47], s88 offen offset:1024 lds
    v_mfma_f32_32x32x16_bf16 v[148:163], a[164:167], a[128:131], v[148:163]
    v_mfma_f32_32x32x16_bf16 v[132:147], a[160:163], a[132:135], v[132:147]
    v_mfma_f32_32x32x16_bf16 v[164:179], a[164:167], a[132:135], v[164:179]
    s_add_u32 m0, s8, 73728
    s_xor_b32 s88, s12, 163840
    s_add_u32 s88, s88, s97
    buffer_load_dwordx4 v10, s[44:47], s88 offen lds
    s_waitcnt vmcnt(24)
    v_mfma_f32_32x32x16_bf16 v[116:131], a[168:171], a[136:139], v[116:131]
    buffer_load_dwordx4 v11, s[44:47], s88 offen offset:1024 lds
    v_mfma_f32_32x32x16_bf16 v[148:163], a[172:175], a[136:139], v[148:163]
    v_mfma_f32_32x32x16_bf16 v[132:147], a[168:171], a[140:143], v[132:147]
    v_mfma_f32_32x32x16_bf16 v[164:179], a[172:175], a[140:143], v[164:179]
    s_add_u32 m0, s8, 57344
    s_xor_b32 s88, s12, 180224
    s_add_u32 s88, s88, s97
    buffer_load_dwordx4 v10, s[44:47], s88 offen lds
    buffer_load_dwordx2 v[248:249], v244, s[36:39], s2 offen sc1
    buffer_load_dwordx4 v[48:51], v28, s[36:39], s3 offen sc1
    s_waitcnt vmcnt(26)
    v_mfma_f32_32x32x16_bf16 v[116:131], a[48:51], a[16:19], v[116:131]
    buffer_load_dwordx4 v11, s[44:47], s88 offen offset:1024 lds
    v_mfma_f32_32x32x16_bf16 v[148:163], a[52:55], a[16:19], v[148:163]
    v_mfma_f32_32x32x16_bf16 v[132:147], a[48:51], a[20:23], v[132:147]
    v_mfma_f32_32x32x16_bf16 v[164:179], a[52:55], a[20:23], v[164:179]
    s_add_u32 m0, s8, 24576
    s_xor_b32 s88, s12, 196608
    s_add_u32 s88, s88, s97
    buffer_load_dwordx4 v10, s[44:47], s88 offen lds
    s_waitcnt vmcnt(26)
    v_mfma_f32_32x32x16_bf16 v[116:131], a[56:59], a[24:27], v[116:131]
    buffer_load_dwordx4 v11, s[44:47], s88 offen offset:1024 lds
    v_mfma_f32_32x32x16_bf16 v[148:163], a[60:63], a[24:27], v[148:163]
    v_mfma_f32_32x32x16_bf16 v[132:147], a[56:59], a[28:31], v[132:147]
    v_mfma_f32_32x32x16_bf16 v[164:179], a[60:63], a[28:31], v[164:179]
    s_add_u32 m0, s8, 90112
    s_xor_b32 s88, s12, 212992
    s_add_u32 s88, s88, s97
    buffer_load_dwordx4 v10, s[44:47], s88 offen lds
    s_waitcnt vmcnt(26)
    v_mfma_f32_32x32x16_bf16 v[116:131], a[176:179], a[144:147], v[116:131]
    buffer_load_dwordx4 v11, s[44:47], s88 offen offset:1024 lds
    v_mfma_f32_32x32x16_bf16 v[148:163], a[180:183], a[144:147], v[148:163]
    v_mfma_f32_32x32x16_bf16 v[132:147], a[176:179], a[148:151], v[132:147]
    v_mfma_f32_32x32x16_bf16 v[164:179], a[180:183], a[148:151], v[164:179]
    s_add_u32 m0, s8, 98304
    s_xor_b32 s88, s12, 229376
    s_add_u32 s88, s88, s97
    buffer_load_dwordx4 v10, s[44:47], s88 offen lds
    s_lshl_b32 s89, s56, 1
    s_add_u32 s89, s89, s60
    s_lshl_b32 s89, s89, 2
    s_lshr_b32 s90, s58, 1
    s_add_u32 s89, s89, s90
    s_lshl_b32 s89, s89, 4
    s_and_b32 s90, s58, 1
    s_lshl_b32 s90, s90, 1
    s_add_u32 s89, s89, s90
    s_add_u32 s89, s89, s61
    s_add_u32 s89, s89, 12
    s_lshl_b32 s89, s89, 3
    s_add_u32 s89, s89, 11534336
    buffer_load_dwordx4 v11, s[44:47], s88 offen offset:1024 lds
    s_waitcnt vmcnt(16)
    s_mov_b64 exec, 1
    buffer_store_dwordx2 v[250:251], v246, s[36:39], s89 offen sc1
    s_mov_b64 exec, -1
    v_mfma_f32_32x32x16_bf16 v[116:131], a[184:187], a[152:155], v[116:131]
    ds_read_b64_tr_b16 v[72:73], v16 offset:24576
    ds_read_b64_tr_b16 v[74:75], v16 offset:25600
    v_mfma_f32_32x32x16_bf16 v[148:163], a[188:191], a[152:155], v[148:163]
    ds_read_b64_tr_b16 v[76:77], v17 offset:24576
    ds_read_b64_tr_b16 v[78:79], v17 offset:25600
    v_mfma_f32_32x32x16_bf16 v[132:147], a[184:187], a[156:159], v[132:147]
    v_mfma_f32_32x32x16_bf16 v[164:179], a[188:191], a[156:159], v[164:179]
    s_add_u32 m0, s8, 114688
    s_xor_b32 s88, s12, 245760
    s_add_u32 s88, s88, s97
    buffer_load_dwordx4 v10, s[44:47], s88 offen lds
    s_waitcnt vmcnt(10)
    s_mov_b32 s90, 0
    v_cmp_eq_u64 vcc, v[248:249], s[92:93]
    s_nop 1
    s_and_b32 vcc_lo, vcc_lo, 240
    s_cmp_eq_u32 vcc_lo, 240
    s_cbranch_scc1 L_POK7
L_PL7:
    s_sleep 2
    buffer_load_dwordx2 v[248:249], v244, s[36:39], s2 offen sc1
    s_waitcnt vmcnt(0)
    s_add_u32 s90, s90, 1
    s_cmp_gt_u32 s90, 200000
    s_cbranch_scc1 L_POK7
    v_cmp_eq_u64 vcc, v[248:249], s[92:93]
    s_nop 1
    s_and_b32 vcc_lo, vcc_lo, 240
    s_cmp_eq_u32 vcc_lo, 240
    s_cbranch_scc0 L_PL7
L_POK7:
    s_nop 4
    s_waitcnt vmcnt(9)
    s_mov_b32 s90, 0
    v_cmp_eq_u64 vcc, v[48:49], s[92:93]
    v_cmp_eq_u64 s[20:21], v[50:51], s[92:93]
    s_nop 1
    s_and_b64 vcc, vcc, s[20:21]
    s_cmp_eq_u64 vcc, -1
    s_cbranch_scc1 L_POK8
L_PL8:
    s_sleep 2
    buffer_load_dwordx4 v[48:51], v28, s[36:39], s3 offen sc1
    s_waitcnt vmcnt(0)
    s_add_u32 s90, s90, 1
    s_cmp_gt_u32 s90, 200000
    s_cbranch_scc1 L_POK8
    v_cmp_eq_u64 vcc, v[48:49], s[92:93]
    v_cmp_eq_u64 s[20:21], v[50:51], s[92:93]
    s_nop 1
    s_and_b64 vcc, vcc, s[20:21]
    s_cmp_eq_u64 vcc, -1
    s_cbranch_scc0 L_PL8
L_POK8:
    s_nop 4
    buffer_load_dwordx4 v11, s[44:47], s88 offen offset:1024 lds
    s_xor_b32 s9, s65, 0
    s_mul_i32 s9, s9, 1088
    s_add_u32 s9, s9, s91
    buffer_load_dwordx4 v[180:183], v18, s[36:39], s9 offen offset:0 sc1
    buffer_load_dwordx4 v[184:187], v4, s[36:39], s9 offen offset:32 sc1
    s_xor_b32 s9, s101, 0
    buffer_load_dwordx4 a[64:67], v28, s[36:39], s9 offen sc1
    s_xor_b32 s9, s101, 32768
    buffer_load_dwordx4 a[68:71], v28, s[36:39], s9 offen sc1
    s_xor_b32 s9, s65, 1
    s_mul_i32 s9, s9, 1088
    s_add_u32 s9, s9, s91
    buffer_load_dwordx4 v[188:191], v18, s[36:39], s9 offen offset:0 sc1
    buffer_load_dwordx4 v[192:195], v4, s[36:39], s9 offen offset:32 sc1
    s_xor_b32 s9, s101, 1024
    buffer_load_dwordx4 a[72:75], v28, s[36:39], s9 offen sc1
    s_xor_b32 s9, s101, 33792
    buffer_load_dwordx4 a[76:79], v28, s[36:39], s9 offen sc1
    s_xor_b32 s9, s65, 2
    s_mul_i32 s9, s9, 1088
    s_add_u32 s9, s9, s91
    buffer_load_dwordx4 v[212:215], v18, s[36:39], s9 offen offset:0 sc1
    buffer_load_dwordx4 v[216:219], v4, s[36:39], s9 offen offset:32 sc1
    s_xor_b32 s9, s101, 2048
    buffer_load_dwordx4 a[192:195], v28, s[36:39], s9 offen sc1
    s_xor_b32 s9, s101, 34816
    buffer_load_dwordx4 a[196:199], v28, s[36:39], s9 offen sc1
    s_xor_b32 s9, s65, 3
    s_mul_i32 s9, s9, 1088
    s_add_u32 s9, s9, s91
    buffer_load_dwordx4 v[220:223], v18, s[36:39], s9 offen offset:0 sc1
    buffer_load_dwordx4 v[224:227], v4, s[36:39], s9 offen offset:32 sc1
    s_xor_b32 s9, s101, 3072
    buffer_load_dwordx4 a[200:203], v28, s[36:39], s9 offen sc1
    s_xor_b32 s9, s101, 35840
    buffer_load_dwordx4 a[204:207], v28, s[36:39], s9 offen sc1
    s_xor_b32 s9, s65, 4
    s_mul_i32 s9, s9, 1088
    s_add_u32 s9, s9, s91
    buffer_load_dwordx4 v[228:231], v18, s[36:39], s9 offen offset:0 sc1
    buffer_load_dwordx4 v[232:235], v4, s[36:39], s9 offen offset:32 sc1
    s_xor_b32 s9, s101, 4096
    buffer_load_dwordx4 a[80:83], v28, s[36:39], s9 offen sc1
    s_xor_b32 s9, s101, 36864
    buffer_load_dwordx4 a[84:87], v28, s[36:39], s9 offen sc1
    s_waitcnt vmcnt(16)
    v_cvt_pk_bf16_f32 v180, v180, v181
    v_cvt_pk_bf16_f32 v181, v182, v183
    v_cvt_pk_bf16_f32 v182, v184, v185
    v_cvt_pk_bf16_f32 v183, v186, v187
    s_nop 1
    v_mfma_f32_32x32x16_bf16 v[84:99], v[180:183], a[64:67], 0
    v_mfma_f32_32x32x16_bf16 v[100:115], v[180:183], a[68:71], 0
    s_waitcnt vmcnt(14)
    v_cvt_pk_bf16_f32 v188, v188, v189
    v_cvt_pk_bf16_f32 v189, v190, v191
    v_cvt_pk_bf16_f32 v190, v192, v193
    v_cvt_pk_bf16_f32 v191, v194, v195
    s_nop 5
    v_add_f32 v92, s13, v92
    v_rcp_f32 v92, v92
    s_nop 0
    v_mul_f32 v84, v84, v92
    v_mul_f32 v85, v85, v92
    v_mul_f32 v86, v86, v92
    v_mul_f32 v87, v87, v92
    v_mul_f32 v88, v88, v92
    v_mul_f32 v89, v89, v92
    v_mul_f32 v90, v90, v92
    v_mul_f32 v91, v91, v92
    v_cvt_pk_bf16_f32 v196, v84, v85
    v_cvt_pk_bf16_f32 v197, v86, v87
    v_cvt_pk_bf16_f32 v198, v88, v89
    v_cvt_pk_bf16_f32 v199, v90, v91
    s_waitcnt vmcnt(12) lgkmcnt(0)
    v_mfma_f32_32x32x16_bf16 v[84:99], v[188:191], a[72:75], 0
    ds_read_b64_tr_b16 v[56:57], v12 offset:0
    ds_read_b64_tr_b16 v[58:59], v12 offset:1024
    v_add_f32 v108, s13, v108
    v_rcp_f32 v108, v108
    s_nop 0
    v_mul_f32 v100, v100, v108
    v_mul_f32 v101, v101, v108
    v_mul_f32 v102, v102, v108
    v_mfma_f32_32x32x16_bf16 v[116:131], v[72:75], v[196:199], v[116:131]
    ds_read_b64_tr_b16 v[60:61], v13 offset:0
    ds_read_b64_tr_b16 v[62:63], v13 offset:1024
    v_mul_f32 v103, v103, v108
    v_mul_f32 v104, v104, v108
    v_mul_f32 v105, v105, v108
    v_mul_f32 v106, v106, v108
    v_mul_f32 v107, v107, v108
    v_cvt_pk_bf16_f32 v200, v100, v101
    v_mfma_f32_32x32x16_bf16 v[148:163], v[76:79], v[196:199], v[148:163]
    s_waitcnt vmcnt(10)
    buffer_load_dwordx2 v[248:249], v244, s[36:39], s2 offen sc1
    v_cvt_pk_bf16_f32 v201, v102, v103
    v_cvt_pk_bf16_f32 v202, v104, v105
    v_cvt_pk_bf16_f32 v203, v106, v107
    v_add_f32 v92, s13, v92
    v_rcp_f32 v92, v92
    v_mfma_f32_32x32x16_bf16 v[100:115], v[188:191], a[76:79], 0
    s_xor_b32 s9, s65, 5
    s_mul_i32 s9, s9, 1088
    s_add_u32 s9, s9, s91
    buffer_load_dwordx4 v[236:239], v18, s[36:39], s9 offen offset:0 sc1
    v_mul_f32 v84, v84, v92
    v_mul_f32 v85, v85, v92
    v_mul_f32 v86, v86, v92
    v_mul_f32 v87, v87, v92
    v_mul_f32 v88, v88, v92
    v_mul_f32 v89, v89, v92
    v_mfma_f32_32x32x16_bf16 v[132:147], v[72:75], v[200:203], v[132:147]
    buffer_load_dwordx4 v[240:243], v4, s[36:39], s9 offen offset:32 sc1
    v_mul_f32 v90, v90, v92
    v_mul_f32 v91, v91, v92
    v_cvt_pk_bf16_f32 v196, v84, v85
    v_cvt_pk_bf16_f32 v197, v86, v87
    v_cvt_pk_bf16_f32 v198, v88, v89
    v_cvt_pk_bf16_f32 v199, v90, v91
    v_mfma_f32_32x32x16_bf16 v[164:179], v[76:79], v[200:203], v[164:179]
    s_xor_b32 s9, s101, 5120
    buffer_load_dwordx4 a[88:91], v28, s[36:39], s9 offen sc1
    v_cvt_pk_bf16_f32 v212, v212, v213
    v_cvt_pk_bf16_f32 v213, v214, v215
    v_cvt_pk_bf16_f32 v214, v216, v217
    v_cvt_pk_bf16_f32 v215, v218, v219
    s_waitcnt vmcnt(12) lgkmcnt(0)
    s_nop 0
    v_mfma_f32_32x32x16_bf16 v[84:99], v[212:215], a[192:195], 0
    ds_read_b64_tr_b16 v[64:65], v14 offset:16384
    ds_read_b64_tr_b16 v[66:67], v14 offset:17408
    v_add_f32 v108, s13, v108
    v_rcp_f32 v108, v108
    s_nop 0
    v_mul_f32 v100, v100, v108
    v_mul_f32 v101, v101, v108
    v_mul_f32 v102, v102, v108
    v_mfma_f32_32x32x16_bf16 v[116:131], v[56:59], v[196:199], v[116:131]
    ds_read_b64_tr_b16 v[68:69], v15 offset:16384
    ds_read_b64_tr_b16 v[70:71], v15 offset:17408
    v_mul_f32 v103, v103, v108
    v_mul_f32 v104, v104, v108
    v_mul_f32 v105, v105, v108
    v_mul_f32 v106, v106, v108
    v_mul_f32 v107, v107, v108
    v_cvt_pk_bf16_f32 v200, v100, v101
    v_mfma_f32_32x32x16_bf16 v[148:163], v[60:63], v[196:199], v[148:163]
    s_waitcnt vmcnt(10)
    s_xor_b32 s9, s101, 37888
    buffer_load_dwordx4 a[92:95], v28, s[36:39], s9 offen sc1
    v_cvt_pk_bf16_f32 v201, v102, v103
    v_cvt_pk_bf16_f32 v202, v104, v105
    v_cvt_pk_bf16_f32 v203, v106, v107
    v_add_f32 v92, s13, v92
    v_rcp_f32 v92, v92
    v_mfma_f32_32x32x16_bf16 v[100:115], v[212:215], a[196:199], 0
    s_xor_b32 s9, s65, 6
    s_mul_i32 s9, s9, 1088
    s_add_u32 s9, s9, s91
    buffer_load_dwordx4 v[40:43], v18, s[36:39], s9 offen offset:0 sc1
    v_mul_f32 v84, v84, v92
    v_mul_f32 v85, v85, v92
    v_mul_f32 v86, v86, v92
    v_mul_f32 v87, v87, v92
    v_mul_f32 v88, v88, v92
    v_mul_f32 v89, v89, v92
    v_mfma_f32_32x32x16_bf16 v[132:147], v[56:59], v[200:203], v[132:147]
    buffer_load_dwordx4 v[44:47], v4, s[36:39], s9 offen offset:32 sc1
    v_mul_f32 v90, v90, v92
    v_mul_f32 v91, v91, v92
    v_cvt_pk_bf16_f32 v196, v84, v85
    v_cvt_pk_bf16_f32 v197, v86, v87
    v_cvt_pk_bf16_f32 v198, v88, v89
    v_cvt_pk_bf16_f32 v199, v90, v91
    v_mfma_f32_32x32x16_bf16 v[164:179], v[60:63], v[200:203], v[164:179]
    s_xor_b32 s9, s101, 6144
    buffer_load_dwordx4 a[208:211], v28, s[36:39], s9 offen sc1
    v_cvt_pk_bf16_f32 v220, v220, v221
    v_cvt_pk_bf16_f32 v221, v222, v223
    v_cvt_pk_bf16_f32 v222, v224, v225
    v_cvt_pk_bf16_f32 v223, v226, v227
    s_waitcnt vmcnt(12) lgkmcnt(0)
    s_nop 0
    v_mfma_f32_32x32x16_bf16 v[84:99], v[220:223], a[200:203], 0
    ds_read_b64_tr_b16 v[72:73], v12 offset:49152
    ds_read_b64_tr_b16 v[74:75], v12 offset:50176
    v_add_f32 v108, s13, v108
    v_rcp_f32 v108, v108
    s_nop 0
    v_mul_f32 v100, v100, v108
    v_mul_f32 v101, v101, v108
    v_mul_f32 v102, v102, v108
    v_mfma_f32_32x32x16_bf16 v[116:131], v[64:67], v[196:199], v[116:131]
    ds_read_b64_tr_b16 v[76:77], v13 offset:49152
    ds_read_b64_tr_b16 v[78:79], v13 offset:50176
    v_mul_f32 v103, v103, v108
    v_mul_f32 v104, v104, v108
    v_mul_f32 v105, v105, v108
    v_mul_f32 v106, v106, v108
    v_mul_f32 v107, v107, v108
    v_cvt_pk_bf16_f32 v200, v100, v101
    v_mfma_f32_32x32x16_bf16 v[148:163], v[68:71], v[196:199], v[148:163]
    s_waitcnt vmcnt(10)
    s_xor_b32 s9, s101, 38912
    buffer_load_dwordx4 a[212:215], v28, s[36:39], s9 offen sc1
    v_cvt_pk_bf16_f32 v201, v102, v103
    v_cvt_pk_bf16_f32 v202, v104, v105
    v_cvt_pk_bf16_f32 v203, v106, v107
    v_add_f32 v92, s13, v92
    v_rcp_f32 v92, v92
    v_mfma_f32_32x32x16_bf16 v[100:115], v[220:223], a[204:207], 0
    s_xor_b32 s9, s65, 7
    s_mul_i32 s9, s9, 1088
    s_add_u32 s9, s9, s91
    buffer_load_dwordx4 v[20:23], v18, s[36:39], s9 offen offset:0 sc1
    v_mul_f32 v84, v84, v92
    v_mul_f32 v85, v85, v92
    v_mul_f32 v86, v86, v92
    v_mul_f32 v87, v87, v92
    v_mul_f32 v88, v88, v92
    v_mul_f32 v89, v89, v92
    v_mfma_f32_32x32x16_bf16 v[132:147], v[64:67], v[200:203], v[132:147]
    buffer_load_dwordx4 v[24:27], v4, s[36:39], s9 offen offset:32 sc1
    v_mul_f32 v90, v90, v92
    v_mul_f32 v91, v91, v92
    v_cvt_pk_bf16_f32 v196, v84, v85
    v_cvt_pk_bf16_f32 v197, v86, v87
    v_cvt_pk_bf16_f32 v198, v88, v89
    v_cvt_pk_bf16_f32 v199, v90, v91
    v_mfma_f32_32x32x16_bf16 v[164:179], v[68:71], v[200:203], v[164:179]
    s_xor_b32 s9, s101, 7168
    buffer_load_dwordx4 a[216:219], v28, s[36:39], s9 offen sc1
    v_cvt_pk_bf16_f32 v228, v228, v229
    v_cvt_pk_bf16_f32 v229, v230, v231
    v_cvt_pk_bf16_f32 v230, v232, v233
    v_cvt_pk_bf16_f32 v231, v234, v235
    s_waitcnt vmcnt(11)
    s_mov_b32 s90, 0
    v_cmp_eq_u64 vcc, v[248:249], s[92:93]
    s_nop 1
    s_and_b32 vcc_lo, vcc_lo, 65280
    s_cmp_eq_u32 vcc_lo, 65280
    s_cbranch_scc1 L_POK9
L_PL9:
    s_sleep 2
    buffer_load_dwordx2 v[248:249], v244, s[36:39], s2 offen sc1
    s_waitcnt vmcnt(0)
    s_add_u32 s90, s90, 1
    s_cmp_gt_u32 s90, 200000
    s_cbranch_scc1 L_POK9
    v_cmp_eq_u64 vcc, v[248:249], s[92:93]
    s_nop 1
    s_and_b32 vcc_lo, vcc_lo, 65280
    s_cmp_eq_u32 vcc_lo, 65280
    s_cbranch_scc0 L_PL9
L_POK9:
    s_nop 4
    s_waitcnt lgkmcnt(0)
    v_mfma_f32_32x32x16_bf16 v[84:99], v[228:231], a[80:83], 0
    ds_read_b64_tr_b16 v[56:57], v12 offset:8192
    ds_read_b64_tr_b16 v[58:59], v12 offset:9216
    v_add_f32 v108, s13, v108
    v_rcp_f32 v108, v108
    s_nop 0
    v_mul_f32 v100, v100, v108
    v_mul_f32 v101, v101, v108
    v_mul_f32 v102, v102, v108
    v_mfma_f32_32x32x16_bf16 v[116:131], v[72:75], v[196:199], v[116:131]
    ds_read_b64_tr_b16 v[60:61], v13 offset:8192
    ds_read_b64_tr_b16 v[62:63], v13 offset:9216
    v_mul_f32 v103, v103, v108
    v_mul_f32 v104, v104, v108
    v_mul_f32 v105, v105, v108
    v_mul_f32 v106, v106, v108
    v_mul_f32 v107, v107, v108
    v_cvt_pk_bf16_f32 v200, v100, v101
    v_mfma_f32_32x32x16_bf16 v[148:163], v[76:79], v[196:199], v[148:163]
    s_waitcnt vmcnt(9)
    s_xor_b32 s9, s101, 39936
    buffer_load_dwordx4 a[220:223], v28, s[36:39], s9 offen sc1
    v_cvt_pk_bf16_f32 v201, v102, v103
    v_cvt_pk_bf16_f32 v202, v104, v105
    v_cvt_pk_bf16_f32 v203, v106, v107
    v_add_f32 v92, s13, v92
    v_rcp_f32 v92, v92
    v_mfma_f32_32x32x16_bf16 v[100:115], v[228:231], a[84:87], 0
    s_xor_b32 s9, s64, 8192
    buffer_load_dwordx4 a[96:99], v28, s[36:39], s9 offen sc1
    v_mul_f32 v84, v84, v92
    v_mul_f32 v85, v85, v92
    v_mul_f32 v86, v86, v92
    v_mul_f32 v87, v87, v92
    v_mul_f32 v88, v88, v92
    v_mul_f32 v89, v89, v92
    v_mfma_f32_32x32x16_bf16 v[132:147], v[72:75], v[200:203], v[132:147]
    s_xor_b32 s9, s64, 139264
    buffer_load_dwordx4 a[100:103], v28, s[36:39], s9 offen sc1
    v_mul_f32 v90, v90, v92
    v_mul_f32 v91, v91, v92
    v_cvt_pk_bf16_f32 v196, v84, v85
    v_cvt_pk_bf16_f32 v197, v86, v87
    v_cvt_pk_bf16_f32 v198, v88, v89
    v_cvt_pk_bf16_f32 v199, v90, v91
    v_mfma_f32_32x32x16_bf16 v[164:179], v[76:79], v[200:203], v[164:179]
    s_xor_b32 s9, s64, 9216
    buffer_load_dwordx4 a[104:107], v28, s[36:39], s9 offen sc1
    v_cvt_pk_bf16_f32 v236, v236, v237
    v_cvt_pk_bf16_f32 v237, v238, v239
    v_cvt_pk_bf16_f32 v238, v240, v241
    v_cvt_pk_bf16_f32 v239, v242, v243
    s_waitcnt vmcnt(11) lgkmcnt(0)
    s_nop 0
    v_mfma_f32_32x32x16_bf16 v[84:99], v[236:239], a[88:91], 0
    ds_read_b64_tr_b16 v[64:65], v12 offset:40960
    ds_read_b64_tr_b16 v[66:67], v12 offset:41984
    v_add_f32 v108, s13, v108
    v_rcp_f32 v108, v108
    s_nop 0
    v_mul_f32 v100, v100, v108
    v_mul_f32 v101, v101, v108
    v_mul_f32 v102, v102, v108
    v_mfma_f32_32x32x16_bf16 v[116:131], v[56:59], v[196:199], v[116:131]
    ds_read_b64_tr_b16 v[68:69], v13 offset:40960
    ds_read_b64_tr_b16 v[70:71], v13 offset:41984
    v_mul_f32 v103, v103, v108
    v_mul_f32 v104, v104, v108
    v_mul_f32 v105, v105, v108
    v_mul_f32 v106, v106, v108
    v_mul_f32 v107, v107, v108
    v_cvt_pk_bf16_f32 v200, v100, v101
    v_mfma_f32_32x32x16_bf16 v[148:163], v[60:63], v[196:199], v[148:163]
    s_waitcnt vmcnt(9)
    s_xor_b32 s9, s64, 140288
    buffer_load_dwordx4 a[108:111], v28, s[36:39], s9 offen sc1
    v_cvt_pk_bf16_f32 v201, v102, v103
    v_cvt_pk_bf16_f32 v202, v104, v105
    v_cvt_pk_bf16_f32 v203, v106, v107
    v_add_f32 v92, s13, v92
    v_rcp_f32 v92, v92
    v_mfma_f32_32x32x16_bf16 v[100:115], v[236:239], a[92:95], 0
    s_xor_b32 s9, s64, 10240
    buffer_load_dwordx4 a[224:227], v28, s[36:39], s9 offen sc1
    v_mul_f32 v84, v84, v92
    v_mul_f32 v85, v85, v92
    v_mul_f32 v86, v86, v92
    v_mul_f32 v87, v87, v92
    v_mul_f32 v88, v88, v92
    v_mul_f32 v89, v89, v92
    v_mfma_f32_32x32x16_bf16 v[132:147], v[56:59], v[200:203], v[132:147]
    s_xor_b32 s9, s64, 141312
    buffer_load_dwordx4 a[228:231], v28, s[36:39], s9 offen sc1
    v_mul_f32 v90, v90, v92
    v_mul_f32 v91, v91, v92
    v_cvt_pk_bf16_f32 v196, v84, v85
    v_cvt_pk_bf16_f32 v197, v86, v87
    v_cvt_pk_bf16_f32 v198, v88, v89
    v_cvt_pk_bf16_f32 v199, v90, v91
    v_mfma_f32_32x32x16_bf16 v[164:179], v[60:63], v[200:203], v[164:179]
    s_xor_b32 s9, s64, 11264
    buffer_load_dwordx4 a[232:235], v28, s[36:39], s9 offen sc1
    v_cvt_pk_bf16_f32 v40, v40, v41
    v_cvt_pk_bf16_f32 v41, v42, v43
    v_cvt_pk_bf16_f32 v42, v44, v45
    v_cvt_pk_bf16_f32 v43, v46, v47
    s_waitcnt vmcnt(11) lgkmcnt(0)
    s_nop 0
    v_mfma_f32_32x32x16_bf16 v[84:99], v[40:43], a[208:211], 0
    ds_read_b64_tr_b16 v[72:73], v14 offset:40960
    ds_read_b64_tr_b16 v[74:75], v14 offset:41984
    v_add_f32 v108, s13, v108
    v_rcp_f32 v108, v108
    s_nop 0
    v_mul_f32 v100, v100, v108
    v_mul_f32 v101, v101, v108
    v_mul_f32 v102, v102, v108
    v_mfma_f32_32x32x16_bf16 v[116:131], v[64:67], v[196:199], v[116:131]
    ds_read_b64_tr_b16 v[76:77], v15 offset:40960
    ds_read_b64_tr_b16 v[78:79], v15 offset:41984
    v_mul_f32 v103, v103, v108
    v_mul_f32 v104, v104, v108
    v_mul_f32 v105, v105, v108
    v_mul_f32 v106, v106, v108
    v_mul_f32 v107, v107, v108
    v_cvt_pk_bf16_f32 v200, v100, v101
    v_mfma_f32_32x32x16_bf16 v[148:163], v[68:71], v[196:199], v[148:163]
    s_waitcnt vmcnt(9)
    s_xor_b32 s9, s64, 142336
    buffer_load_dwordx4 a[236:239], v28, s[36:39], s9 offen sc1
    v_cvt_pk_bf16_f32 v201, v102, v103
    v_cvt_pk_bf16_f32 v202, v104, v105
    v_cvt_pk_bf16_f32 v203, v106, v107
    v_add_f32 v92, s13, v92
    v_rcp_f32 v92, v92
    v_mfma_f32_32x32x16_bf16 v[100:115], v[40:43], a[212:215], 0
    s_xor_b32 s9, s64, 12288
    buffer_load_dwordx4 a[112:115], v28, s[36:39], s9 offen sc1
    v_mul_f32 v84, v84, v92
    v_mul_f32 v85, v85, v92
    v_mul_f32 v86, v86, v92
    v_mul_f32 v87, v87, v92
    v_mul_f32 v88, v88, v92
    v_mul_f32 v89, v89, v92
    v_mfma_f32_32x32x16_bf16 v[132:147], v[64:67], v[200:203], v[132:147]
    s_xor_b32 s9, s64, 143360
    buffer_load_dwordx4 a[116:119], v28, s[36:39], s9 offen sc1
    v_mul_f32 v90, v90, v92
    v_mul_f32 v91, v91, v92
    v_cvt_pk_bf16_f32 v196, v84, v85
    v_cvt_pk_bf16_f32 v197, v86, v87
    v_cvt_pk_bf16_f32 v198, v88, v89
    v_cvt_pk_bf16_f32 v199, v90, v91
    v_mfma_f32_32x32x16_bf16 v[164:179], v[68:71], v[200:203], v[164:179]
    s_xor_b32 s9, s64, 13312
    buffer_load_dwordx4 a[120:123], v28, s[36:39], s9 offen sc1
    v_cvt_pk_bf16_f32 v20, v20, v21
    v_cvt_pk_bf16_f32 v21, v22, v23
    v_cvt_pk_bf16_f32 v22, v24, v25
    v_cvt_pk_bf16_f32 v23, v26, v27
    s_waitcnt vmcnt(11) lgkmcnt(0)
    s_nop 0
    v_mfma_f32_32x32x16_bf16 v[84:99], v[20:23], a[216:219], 0
    ds_read_b64_tr_b16 v[56:57], v14 offset:57344
    ds_read_b64_tr_b16 v[58:59], v14 offset:58368
    v_add_f32 v108, s13, v108
    v_rcp_f32 v108, v108
    s_nop 0
    v_mul_f32 v100, v100, v108
    v_mul_f32 v101, v101, v108
    v_mul_f32 v102, v102, v108
    v_mfma_f32_32x32x16_bf16 v[116:131], v[72:75], v[196:199], v[116:131]
    ds_read_b64_tr_b16 v[60:61], v15 offset:57344
    ds_read_b64_tr_b16 v[62:63], v15 offset:58368
    v_mul_f32 v103, v103, v108
    v_mul_f32 v104, v104, v108
    v_mul_f32 v105, v105, v108
    v_mul_f32 v106, v106, v108
    v_mul_f32 v107, v107, v108
    v_cvt_pk_bf16_f32 v200, v100, v101
    v_mfma_f32_32x32x16_bf16 v[148:163], v[76:79], v[196:199], v[148:163]
    s_xor_b32 s9, s64, 144384
    buffer_load_dwordx4 a[124:127], v28, s[36:39], s9 offen sc1
    v_cvt_pk_bf16_f32 v201, v102, v103
    v_cvt_pk_bf16_f32 v202, v104, v105
    v_cvt_pk_bf16_f32 v203, v106, v107
    v_add_f32 v92, s13, v92
    v_rcp_f32 v92, v92
    v_mfma_f32_32x32x16_bf16 v[100:115], v[20:23], a[220:223], 0
    s_xor_b32 s9, s64, 14336
    buffer_load_dwordx4 a[240:243], v28, s[36:39], s9 offen sc1
    v_mul_f32 v84, v84, v92
    v_mul_f32 v85, v85, v92
    v_mul_f32 v86, v86, v92
    v_mul_f32 v87, v87, v92
    v_mul_f32 v88, v88, v92
    v_mul_f32 v89, v89, v92
    v_mfma_f32_32x32x16_bf16 v[132:147], v[72:75], v[200:203], v[132:147]
    s_add_u32 m0, s8, 147456
    s_add_u32 s88, s97, 262144
    buffer_load_dwordx4 v10, s[44:47], s88 offen lds
    v_mul_f32 v90, v90, v92
    v_mul_f32 v91, v91, v92
    v_cvt_pk_bf16_f32 v196, v84, v85
    v_cvt_pk_bf16_f32 v197, v86, v87
    v_cvt_pk_bf16_f32 v198, v88, v89
    v_cvt_pk_bf16_f32 v199, v90, v91
    v_mfma_f32_32x32x16_bf16 v[164:179], v[76:79], v[200:203], v[164:179]
    buffer_load_dwordx4 v11, s[44:47], s88 offen offset:1024 lds
    s_waitcnt lgkmcnt(0)
    v_mfma_f32_32x32x16_bf16 v[116:131], v[56:59], v[196:199], v[116:131]
    ds_read_b64_tr_b16 v[64:65], v14 offset:0
    ds_read_b64_tr_b16 v[66:67], v14 offset:1024
    v_add_f32 v108, s13, v108
    v_rcp_f32 v108, v108
    s_nop 0
    v_mul_f32 v100, v100, v108
    v_mul_f32 v101, v101, v108
    v_mul_f32 v102, v102, v108
    v_mfma_f32_32x32x16_bf16 v[148:163], v[60:63], v[196:199], v[148:163]
    ds_read_b64_tr_b16 v[68:69], v15 offset:0
    ds_read_b64_tr_b16 v[70:71], v15 offset:1024
    v_mul_f32 v103, v103, v108
    v_mul_f32 v104, v104, v108
    v_mul_f32 v105, v105, v108
    v_mul_f32 v106, v106, v108
    v_mul_f32 v107, v107, v108
    v_cvt_pk_bf16_f32 v200, v100, v101
    v_cvt_pk_bf16_f32 v201, v102, v103
    v_cvt_pk_bf16_f32 v202, v104, v105
    v_cvt_pk_bf16_f32 v203, v106, v107
    s_nop 1
    v_mfma_f32_32x32x16_bf16 v[132:147], v[56:59], v[200:203], v[132:147]
    s_xor_b32 s9, s64, 15360
    buffer_load_dwordx4 a[248:251], v28, s[36:39], s9 offen sc1
    v_mfma_f32_32x32x16_bf16 v[164:179], v[60:63], v[200:203], v[164:179]
    s_add_u32 m0, s8, 32768
    s_add_u32 s88, s97, 278528
    buffer_load_dwordx4 v10, s[44:47], s88 offen lds
    s_waitcnt vmcnt(15) lgkmcnt(0)
    v_mfma_f32_32x32x16_bf16 v[116:131], v[64:67], a[96:99], v[116:131]
    ds_read_b64_tr_b16 v[72:73], v12 offset:16384
    ds_read_b64_tr_b16 v[74:75], v12 offset:17408
    buffer_load_dwordx4 v11, s[44:47], s88 offen offset:1024 lds
    v_mfma_f32_32x32x16_bf16 v[148:163], v[68:71], a[96:99], v[148:163]
    ds_read_b64_tr_b16 v[76:77], v13 offset:16384
    ds_read_b64_tr_b16 v[78:79], v13 offset:17408
    s_add_u32 s9, s99, 16384
    buffer_load_dwordx4 a[0:3], v28, s[36:39], s9 offen sc1
    v_mfma_f32_32x32x16_bf16 v[132:147], v[64:67], a[100:103], v[132:147]
    s_add_u32 m0, s8, 131072
    s_add_u32 s88, s97, 294912
    buffer_load_dwordx4 v10, s[44:47], s88 offen lds
    v_mfma_f32_32x32x16_bf16 v[164:179], v[68:71], a[100:103], v[164:179]
    buffer_load_dwordx4 v11, s[44:47], s88 offen offset:1024 lds
    buffer_load_dwordx4 v[84:87], v19, s[24:27], s0 offen
    buffer_load_dwordx4 v[88:91], v19, s[24:27], s1 offen
    s_waitcnt vmcnt(19) lgkmcnt(0)
    v_mfma_f32_32x32x16_bf16 v[116:131], v[72:75], a[104:107], v[116:131]
    ds_read_b64_tr_b16 v[56:57], v14 offset:8192
    ds_read_b64_tr_b16 v[58:59], v14 offset:9216
    s_add_u32 s9, s99, 17408
    buffer_load_dwordx4 a[8:11], v28, s[36:39], s9 offen sc1
    v_and_b32 v212, 31, v1
    v_mfma_f32_32x32x16_bf16 v[148:163], v[76:79], a[104:107], v[148:163]
    ds_read_b64_tr_b16 v[60:61], v15 offset:8192
    ds_read_b64_tr_b16 v[62:63], v15 offset:9216
    s_add_u32 m0, s8, 139264
    s_add_u32 s88, s97, 311296
    buffer_load_dwordx4 v10, s[44:47], s88 offen lds
    v_mfma_f32_32x32x16_bf16 v[132:147], v[72:75], a[108:111], v[132:147]
    buffer_load_dwordx4 v11, s[44:47], s88 offen offset:1024 lds
    v_lshrrev_b32 v213, 3, v212
    v_lshlrev_b32 v213, 13, v213
    v_and_b32 v214, 7, v1
    v_lshl_add_u32 v213, v214, 8, v213
    v_mfma_f32_32x32x16_bf16 v[164:179], v[76:79], a[108:111], v[164:179]
    s_add_u32 s9, s99, 18432
    buffer_load_dwordx4 a[128:131], v28, s[36:39], s9 offen sc1
    v_add_u32 v213, s8, v213
    v_lshrrev_b32 v215, 5, v1
    v_add_u32 v216, 0, v215
    s_waitcnt vmcnt(21) lgkmcnt(0)
    v_mfma_f32_32x32x16_bf16 v[116:131], v[56:59], a[224:227], v[116:131]
    ds_read_b64_tr_b16 v[64:65], v12 offset:57344
    ds_read_b64_tr_b16 v[66:67], v12 offset:58368
    s_add_u32 m0, s8, 155648
    s_add_u32 s88, s97, 327680
    buffer_load_dwordx4 v10, s[44:47], s88 offen lds
    v_mfma_f32_32x32x16_bf16 v[148:163], v[60:63], a[224:227], v[148:163]
    ds_read_b64_tr_b16 v[68:69], v13 offset:57344
    ds_read_b64_tr_b16 v[70:71], v13 offset:58368
    buffer_load_dwordx4 v11, s[44:47], s88 offen offset:1024 lds
    v_xor_b32 v216, v216, v214
    v_lshl_add_u32 v220, v216, 4, v213
    v_mfma_f32_32x32x16_bf16 v[132:147], v[56:59], a[228:231], v[132:147]
    s_add_u32 s9, s99, 19456
    buffer_load_dwordx4 a[136:139], v28, s[36:39], s9 offen sc1
    v_add_u32 v216, 2, v215
    v_xor_b32 v216, v216, v214
    v_lshl_add_u32 v221, v216, 4, v213
    v_mfma_f32_32x32x16_bf16 v[164:179], v[60:63], a[228:231], v[164:179]
    s_add_u32 m0, s8, 0
    s_add_u32 s88, s97, 344064
    buffer_load_dwordx4 v10, s[44:47], s88 offen lds
    v_add_u32 v216, 4, v215
    v_xor_b32 v216, v216, v214
    buffer_load_dwordx4 v11, s[44:47], s88 offen offset:1024 lds
    s_waitcnt vmcnt(24) lgkmcnt(0)
    v_mfma_f32_32x32x16_bf16 v[116:131], v[64:67], a[232:235], v[116:131]
    ds_read_b64_tr_b16 v[72:73], v12 offset:24576
    ds_read_b64_tr_b16 v[74:75], v12 offset:25600
    s_add_u32 s9, s100, 20480
    buffer_load_dwordx4 a[16:19], v28, s[36:39], s9 offen sc1
    v_lshl_add_u32 v222, v216, 4, v213
    v_mfma_f32_32x32x16_bf16 v[148:163], v[68:71], a[232:235], v[148:163]
    ds_read_b64_tr_b16 v[76:77], v13 offset:24576
    ds_read_b64_tr_b16 v[78:79], v13 offset:25600
    s_add_u32 s9, s100, 21504
    buffer_load_dwordx4 a[24:27], v28, s[36:39], s9 offen sc1
    v_add_u32 v216, 6, v215
    v_mfma_f32_32x32x16_bf16 v[132:147], v[64:67], a[236:239], v[132:147]
    ds_read_b64_tr_b16 v[180:181], v14 offset:32768
    ds_read_b64_tr_b16 v[182:183], v14 offset:33792
    s_xor_b32 s9, s64, 145408
    buffer_load_dwordx4 a[244:247], v28, s[36:39], s9 offen sc1
    v_xor_b32 v216, v216, v214
    v_mfma_f32_32x32x16_bf16 v[164:179], v[68:71], a[236:239], v[164:179]
    ds_read_b64_tr_b16 v[184:185], v15 offset:32768
    ds_read_b64_tr_b16 v[186:187], v15 offset:33792
    s_xor_b32 s9, s64, 146432
    buffer_load_dwordx4 a[252:255], v28, s[36:39], s9 offen sc1
    v_lshl_add_u32 v223, v216, 4, v213
    s_waitcnt vmcnt(26) lgkmcnt(4)
    v_mfma_f32_32x32x16_bf16 v[116:131], v[72:75], a[112:115], v[116:131]
    ds_read_b64_tr_b16 v[56:57], v14 offset:24576
    ds_read_b64_tr_b16 v[58:59], v14 offset:25600
    s_add_u32 s9, s99, 147456
    buffer_load_dwordx4 a[4:7], v28, s[36:39], s9 offen sc1
    v_lshrrev_b32 v212, 6, v0
    v_mfma_f32_32x32x16_bf16 v[148:163], v[76:79], a[112:115], v[148:163]
    ds_read_b64_tr_b16 v[60:61], v15 offset:24576
    ds_read_b64_tr_b16 v[62:63], v15 offset:25600
    s_add_u32 s9, s99, 148480
    buffer_load_dwordx4 a[12:15], v28, s[36:39], s9 offen sc1
    v_lshlrev_b32 v212, 13, v212
    v_mfma_f32_32x32x16_bf16 v[132:147], v[72:75], a[116:119], v[132:147]
    ds_read_b64_tr_b16 v[188:189], v14 offset:49152
    ds_read_b64_tr_b16 v[190:191], v14 offset:50176
    s_add_u32 s9, s99, 149504
    buffer_load_dwordx4 a[132:135], v28, s[36:39], s9 offen sc1
    v_bfe_u32 v213, v0, 3, 3
    v_mfma_f32_32x32x16_bf16 v[164:179], v[76:79], a[116:119], v[164:179]
    ds_read_b64_tr_b16 v[192:193], v15 offset:49152
    ds_read_b64_tr_b16 v[194:195], v15 offset:50176
    s_add_u32 s9, s99, 150528
    buffer_load_dwordx4 a[140:143], v28, s[36:39], s9 offen sc1
    v_lshl_add_u32 v212, v213, 8, v212
    s_waitcnt vmcnt(28) lgkmcnt(4)
    v_mfma_f32_32x32x16_bf16 v[116:131], v[56:59], a[120:123], v[116:131]
    s_waitcnt vmcnt(25)
    ds_read_b64_tr_b16 v[196:197], v16 offset:16384
    ds_read_b64_tr_b16 v[198:199], v16 offset:17408
    s_add_u32 s9, s100, 151552
    buffer_load_dwordx4 a[20:23], v28, s[36:39], s9 offen sc1
    v_lshlrev_b32 v214, 1, v214
    v_mfma_f32_32x32x16_bf16 v[148:163], v[60:63], a[120:123], v[148:163]
    ds_read_b64_tr_b16 v[200:201], v17 offset:16384
    ds_read_b64_tr_b16 v[202:203], v17 offset:17408
    s_add_u32 s9, s100, 152576
    buffer_load_dwordx4 a[28:31], v28, s[36:39], s9 offen sc1
    v_xor_b32 v214, v214, v213
    v_mfma_f32_32x32x16_bf16 v[132:147], v[56:59], a[124:127], v[132:147]
    s_waitcnt vmcnt(24)
    ds_read_b64_tr_b16 v[204:205], v12 offset:32768
    ds_read_b64_tr_b16 v[206:207], v12 offset:33792
    v_lshl_add_u32 v216, v214, 4, v212
    v_xor_b32 v217, 16, v216
    v_mfma_f32_32x32x16_bf16 v[164:179], v[60:63], a[124:127], v[164:179]
    ds_read_b64_tr_b16 v[208:209], v13 offset:32768
    ds_read_b64_tr_b16 v[210:211], v13 offset:33792
    v_mfma_f32_32x32x16_bf16 v[116:131], v[180:183], a[240:243], v[116:131]
    s_waitcnt vmcnt(21)
    ds_read_b64_tr_b16 v[224:225], v16 offset:0
    ds_read_b64_tr_b16 v[226:227], v16 offset:1024
    v_mfma_f32_32x32x16_bf16 v[148:163], v[184:187], a[240:243], v[148:163]
    ds_read_b64_tr_b16 v[228:229], v17 offset:0
    ds_read_b64_tr_b16 v[230:231], v17 offset:1024
    s_waitcnt lgkmcnt(12)
    s_waitcnt vmcnt(19)
    v_mfma_f32_32x32x16_bf16 v[116:131], v[188:191], a[248:251], v[116:131]
    s_waitcnt vmcnt(16)
    ds_read_b64_tr_b16 v[232:233], v16 offset:8192
    ds_read_b64_tr_b16 v[234:235], v16 offset:9216
    v_lshlrev_b32 v92, 16, v84
    v_and_b32 v93, 0xffff0000, v84
    v_lshlrev_b32 v94, 16, v85
    v_and_b32 v95, 0xffff0000, v85
    v_mfma_f32_32x32x16_bf16 v[148:163], v[192:195], a[248:251], v[148:163]
    ds_read_b64_tr_b16 v[236:237], v17 offset:8192
    ds_read_b64_tr_b16 v[238:239], v17 offset:9216
    v_lshlrev_b32 v96, 16, v86
    v_and_b32 v97, 0xffff0000, v86
    v_lshlrev_b32 v98, 16, v87
    v_and_b32 v99, 0xffff0000, v87
    s_waitcnt lgkmcnt(12)
    v_mfma_f32_32x32x16_bf16 v[116:131], v[196:199], a[0:3], v[116:131]
    s_waitcnt vmcnt(13)
    ds_read_b64_tr_b16 v[40:41], v16 offset:24576
    ds_read_b64_tr_b16 v[42:43], v16 offset:25600
    v_lshlrev_b32 v100, 16, v88
    v_and_b32 v101, 0xffff0000, v88
    v_lshlrev_b32 v102, 16, v89
    v_and_b32 v103, 0xffff0000, v89
    v_mfma_f32_32x32x16_bf16 v[148:163], v[200:203], a[0:3], v[148:163]
    ds_read_b64_tr_b16 v[44:45], v17 offset:24576
    ds_read_b64_tr_b16 v[46:47], v17 offset:25600
    v_lshlrev_b32 v104, 16, v90
    v_and_b32 v105, 0xffff0000, v90
    v_lshlrev_b32 v106, 16, v91
    v_and_b32 v107, 0xffff0000, v91
    s_waitcnt lgkmcnt(12)
    v_mfma_f32_32x32x16_bf16 v[116:131], v[204:207], a[8:11], v[116:131]
    s_waitcnt vmcnt(10)
    ds_read_b64_tr_b16 v[48:49], v12 offset:0
    ds_read_b64_tr_b16 v[50:51], v12 offset:1024
    v_mfma_f32_32x32x16_bf16 v[148:163], v[208:211], a[8:11], v[148:163]
    ds_read_b64_tr_b16 v[52:53], v13 offset:0
    ds_read_b64_tr_b16 v[54:55], v13 offset:1024
    s_waitcnt lgkmcnt(12)
    v_mfma_f32_32x32x16_bf16 v[116:131], v[224:227], a[128:131], v[116:131]
    v_mfma_f32_32x32x16_bf16 v[148:163], v[228:231], a[128:131], v[148:163]
    s_waitcnt lgkmcnt(8)
    v_mfma_f32_32x32x16_bf16 v[116:131], v[232:235], a[136:139], v[116:131]
    v_mfma_f32_32x32x16_bf16 v[148:163], v[236:239], a[136:139], v[148:163]
    s_waitcnt vmcnt(9) lgkmcnt(4)
    v_mfma_f32_32x32x16_bf16 v[116:131], v[40:43], a[16:19], v[116:131]
    v_mfma_f32_32x32x16_bf16 v[148:163], v[44:47], a[16:19], v[148:163]
    s_waitcnt vmcnt(8) lgkmcnt(0)
    v_mfma_f32_32x32x16_bf16 v[116:131], v[48:51], a[24:27], v[116:131]
    v_mfma_f32_32x32x16_bf16 v[148:163], v[52:55], a[24:27], v[148:163]
    s_waitcnt vmcnt(7)
    v_mfma_f32_32x32x16_bf16 v[132:147], v[180:183], a[244:247], v[132:147]
    v_mfma_f32_32x32x16_bf16 v[164:179], v[184:187], a[244:247], v[164:179]
    s_waitcnt vmcnt(6)
    v_mfma_f32_32x32x16_bf16 v[132:147], v[188:191], a[252:255], v[132:147]
    s_nop 5
    ds_write_b128 v220, v[116:119] offset:0
    v_mfma_f32_32x32x16_bf16 v[164:179], v[192:195], a[252:255], v[164:179]
    ds_write_b128 v221, v[120:123] offset:0
    s_waitcnt vmcnt(5)
    v_mfma_f32_32x32x16_bf16 v[132:147], v[196:199], a[4:7], v[132:147]
    ds_write_b128 v222, v[124:127] offset:0
    v_mfma_f32_32x32x16_bf16 v[164:179], v[200:203], a[4:7], v[164:179]
    ds_write_b128 v223, v[128:131] offset:0
    s_waitcnt vmcnt(4)
    v_mfma_f32_32x32x16_bf16 v[132:147], v[204:207], a[12:15], v[132:147]
    ds_write_b128 v220, v[148:151] offset:128
    v_mfma_f32_32x32x16_bf16 v[164:179], v[208:211], a[12:15], v[164:179]
    ds_write_b128 v221, v[152:155] offset:128
    s_waitcnt vmcnt(3)
    v_mfma_f32_32x32x16_bf16 v[132:147], v[224:227], a[132:135], v[132:147]
    ds_write_b128 v222, v[156:159] offset:128
    v_mfma_f32_32x32x16_bf16 v[164:179], v[228:231], a[132:135], v[164:179]
    ds_write_b128 v223, v[160:163] offset:128
    s_waitcnt vmcnt(2)
    v_mfma_f32_32x32x16_bf16 v[132:147], v[232:235], a[140:143], v[132:147]
    v_mfma_f32_32x32x16_bf16 v[164:179], v[236:239], a[140:143], v[164:179]
    s_waitcnt vmcnt(1)
    v_mfma_f32_32x32x16_bf16 v[132:147], v[40:43], a[20:23], v[132:147]
    v_mfma_f32_32x32x16_bf16 v[164:179], v[44:47], a[20:23], v[164:179]
    s_waitcnt vmcnt(0)
    v_mfma_f32_32x32x16_bf16 v[132:147], v[48:51], a[28:31], v[132:147]
    v_mfma_f32_32x32x16_bf16 v[164:179], v[52:55], a[28:31], v[164:179]
    s_nop 10
    ds_write_b128 v220, v[132:135] offset:32768
    ds_write_b128 v221, v[136:139] offset:32768
    ds_write_b128 v222, v[140:143] offset:32768
    ds_write_b128 v223, v[144:147] offset:32768
    ds_write_b128 v220, v[164:167] offset:32896
    ds_write_b128 v221, v[168:171] offset:32896
    ds_write_b128 v222, v[172:175] offset:32896
    ds_write_b128 v223, v[176:179] offset:32896
    s_waitcnt lgkmcnt(0)
    s_barrier
    ds_read_b128 v[116:119], v216 offset:0
    ds_read_b128 v[120:123], v217 offset:0
    ds_read_b128 v[124:127], v216 offset:2048
    ds_read_b128 v[128:131], v217 offset:2048
    ds_read_b128 v[148:151], v216 offset:4096
    ds_read_b128 v[152:155], v217 offset:4096
    ds_read_b128 v[156:159], v216 offset:6144
    ds_read_b128 v[160:163], v217 offset:6144
    ds_read_b128 v[132:135], v216 offset:32768
    ds_read_b128 v[136:139], v217 offset:32768
    ds_read_b128 v[140:143], v216 offset:34816
    ds_read_b128 v[144:147], v217 offset:34816
    ds_read_b128 v[164:167], v216 offset:36864
    ds_read_b128 v[168:171], v217 offset:36864
    ds_read_b128 v[172:175], v216 offset:38912
    ds_read_b128 v[176:179], v217 offset:38912
    s_waitcnt lgkmcnt(8)
    v_pk_add_f32 v[116:117], v[116:117], v[124:125]
    v_pk_add_f32 v[148:149], v[148:149], v[156:157]
    v_pk_add_f32 v[118:119], v[118:119], v[126:127]
    v_pk_add_f32 v[150:151], v[150:151], v[158:159]
    v_pk_add_f32 v[120:121], v[120:121], v[128:129]
    v_pk_add_f32 v[152:153], v[152:153], v[160:161]
    v_pk_add_f32 v[122:123], v[122:123], v[130:131]
    v_pk_add_f32 v[154:155], v[154:155], v[162:163]
    v_pk_add_f32 v[116:117], v[116:117], v[92:93]
    v_pk_add_f32 v[118:119], v[118:119], v[94:95]
    v_pk_add_f32 v[120:121], v[120:121], v[96:97]
    v_pk_add_f32 v[122:123], v[122:123], v[98:99]
    v_pk_add_f32 v[116:117], v[116:117], v[148:149]
    v_pk_add_f32 v[118:119], v[118:119], v[150:151]
    v_pk_add_f32 v[120:121], v[120:121], v[152:153]
    v_pk_add_f32 v[122:123], v[122:123], v[154:155]
    v_cvt_pk_bf16_f32 v124, v116, v117
    v_cvt_pk_bf16_f32 v125, v118, v119
    v_cvt_pk_bf16_f32 v126, v120, v121
    v_cvt_pk_bf16_f32 v127, v122, v123
    buffer_store_dwordx4 v[124:127], v19, s[52:55], s0 offen
    s_waitcnt lgkmcnt(0)
    v_pk_add_f32 v[132:133], v[132:133], v[140:141]
    v_pk_add_f32 v[164:165], v[164:165], v[172:173]
    v_pk_add_f32 v[134:135], v[134:135], v[142:143]
    v_pk_add_f32 v[166:167], v[166:167], v[174:175]
    v_pk_add_f32 v[136:137], v[136:137], v[144:145]
    v_pk_add_f32 v[168:169], v[168:169], v[176:177]
    v_pk_add_f32 v[138:139], v[138:139], v[146:147]
    v_pk_add_f32 v[170:171], v[170:171], v[178:179]
    v_pk_add_f32 v[132:133], v[132:133], v[100:101]
    v_pk_add_f32 v[134:135], v[134:135], v[102:103]
    v_pk_add_f32 v[136:137], v[136:137], v[104:105]
    v_pk_add_f32 v[138:139], v[138:139], v[106:107]
    v_pk_add_f32 v[132:133], v[132:133], v[164:165]
    v_pk_add_f32 v[134:135], v[134:135], v[166:167]
    v_pk_add_f32 v[136:137], v[136:137], v[168:169]
    v_pk_add_f32 v[138:139], v[138:139], v[170:171]
    v_cvt_pk_bf16_f32 v140, v132, v133
    v_cvt_pk_bf16_f32 v141, v134, v135
    v_cvt_pk_bf16_f32 v142, v136, v137
    v_cvt_pk_bf16_f32 v143, v138, v139
    buffer_store_dwordx4 v[140:143], v19, s[52:55], s1 offen
    s_endpgm
L_END:
    s_endpgm
.section .rodata,"a"
.p2align 6
.amdhsa_kernel parallel_sum__linear_attn_block__dense_activation_relu__prompt_kernel
  .amdhsa_next_free_vgpr 512
  .amdhsa_next_free_sgpr 102
  .amdhsa_accum_offset 256
  .amdhsa_group_segment_fixed_size 0
  .amdhsa_kernarg_size 72
  .amdhsa_user_sgpr_count 2
  .amdhsa_user_sgpr_kernarg_segment_ptr 1
  .amdhsa_system_sgpr_workgroup_id_x 1
.end_amdhsa_kernel
```
